```python
import torch

def _softmax(x, axis=-1):
    return torch.softmax(x, dim=axis)
def _gelu(x):
    return torch.nn.functional.gelu(x, approximate="tanh")
def _silu(x):
    return torch.nn.functional.silu(x)
def _sigmoid(x):
    return torch.sigmoid(x)
def _layernorm(x, axis=-1, eps=1e-5):
    m = x.mean(dim=axis, keepdim=True)
    v = x.var(dim=axis, keepdim=True, unbiased=False)
    return (x - m) / torch.sqrt(v + eps)
def _scatter_add(tgt, idx, src, axis=0):
    return tgt.clone().index_add_(axis, idx, src)
def _segment_sum(src, seg, n):
    out = torch.zeros((n,) + src.shape[1:], dtype=src.dtype)
    return out.index_add_(0, seg, src)
def _pad(x, pw):
    flat = tuple(v for pair in reversed(pw) for v in pair)
    return torch.nn.functional.pad(x, flat)

kernel_name = 'recurrent_scan__ssm_conv_s4d__dense_activation_squared_relu__prompt'

def setup_inputs():

    _w = (lambda a: (lambda t: t.to(torch.bfloat16) if t.is_floating_point() else t)(torch.as_tensor(a)))
    def _A_setup():
        Bsz, L, D, N = 1, 2048, 448, 256
        return {
            "u": _w((lambda *s: torch.randn(*s, dtype=torch.bfloat16) * 0.05)(Bsz, L, D)),
            "log_A_real": _w((lambda *s: torch.randn(*s, dtype=torch.bfloat16) * 3.2)(D, N) * 0.5),
            "A_imag": _w((lambda *s: torch.randn(*s, dtype=torch.bfloat16) * 0.05)(D, N) * 3.14),
            "C_real": _w((lambda *s: torch.randn(*s, dtype=torch.bfloat16) * 0.2)(D, N) / N ** 0.5),
            "C_imag": _w((lambda *s: torch.randn(*s, dtype=torch.bfloat16) * 0.2)(D, N) / N ** 0.5),
            "log_dt": _w((lambda *s: torch.randn(*s, dtype=torch.bfloat16) * 0.05)(D) * 0.5 - 4.0),
            "D_skip": _w((lambda *s: torch.randn(*s, dtype=torch.bfloat16) * 0.05)(D)),
        }
    _A_in = _A_setup()

    def _B_setup():
        B, S, D, F = 1, 2048, 448, 1792
        return {
            "x": _w((lambda *s: torch.randn(*s, dtype=torch.bfloat16) * 0.05)(B, S, D)),
            "w1": _w((lambda *s: torch.randn(*s, dtype=torch.bfloat16) * 0.05)(D, F)),
            "b1": _w((lambda *s: torch.randn(*s, dtype=torch.bfloat16) * 0.4)(F)),
            "w2": _w((lambda *s: torch.randn(*s, dtype=torch.bfloat16) * 0.05)(F, D)),
            "b2": _w((lambda *s: torch.randn(*s, dtype=torch.bfloat16) * 0.8)(D)),
        }
    _B_in = _B_setup()

    return {
        "A_u": _A_in["u"],
        "A_log_A_real": _A_in["log_A_real"],
        "A_A_imag": _A_in["A_imag"],
        "A_C_real": _A_in["C_real"],
        "A_C_imag": _A_in["C_imag"],
        "A_log_dt": _A_in["log_dt"],
        "A_D_skip": _A_in["D_skip"],
        "B_x": _B_in["x"],
        "B_w1": _B_in["w1"],
        "B_b1": _B_in["b1"],
        "B_w2": _B_in["w2"],
        "B_b2": _B_in["b2"],
    }

def reference(A_u, A_log_A_real, A_A_imag, A_C_real, A_C_imag, A_log_dt, A_D_skip, B_x, B_w1, B_b1, B_w2, B_b2):
    def _A_ref(u, log_A_real, A_imag, C_real, C_imag, log_dt, D_skip):
        L = u.shape[1]
        dt = torch.exp(log_dt)
        A = -torch.exp(log_A_real) + 1j * A_imag
        C = (C_real + 1j * C_imag) * dt[:, None]
        pos = (lambda x, dt: x.to(dt))(torch.arange(L), log_dt.dtype)
        P = torch.exp((A * dt[:, None])[:, :, None] * pos[None, None, :])
        K = 2.0 * torch.einsum("dn,dnl->dl", C, P).real
        L2 = 2 * L
        u_t = (lambda x, *d: x.permute(*d))(u, 0, 2, 1)
        Kf = (lambda x, *a, **k: torch.fft.rfft(x.float(), *a, **k))(K, L2)
        Uf = (lambda x, *a, **k: torch.fft.rfft(x.float(), *a, **k))(u_t, L2)
        y = (lambda x, *a, **k: torch.fft.irfft(x, *a, **k).to(torch.bfloat16))(Uf * Kf[None, :, :], L2)[:, :, :L]
        y = (lambda x, *d: x.permute(*d))(y, 0, 2, 1)
        return y + u * D_skip[None, None, :]

    def _B_ref(x, w1, b1, w2, b2):
        h = torch.einsum("bsd,df->bsf", x, w1) + b1
        zero = torch.zeros_like(h)
        r = torch.where(h > zero, h, zero)
        h = r * r
        out = torch.einsum("bsf,fd->bsd", h, w2) + b2
        return out

    x = A_u
    xn = _layernorm(x, axis=-1)
    s = _A_ref(xn, A_log_A_real, A_A_imag, A_C_real, A_C_imag, A_log_dt, A_D_skip)
    g = _silu(_B_ref(xn, B_w1, B_b1, B_w2, B_b2))
    return x + s * g
```

```asm
; @launch kernel=prep_kernel grid=(1296,1,1) block=(256,1,1) lds=69632
; @launch kernel=mid_kernel grid=(336,1,1) block=(256,1,1) lds=98304
; @launch kernel=fin_kernel grid=(224,1,1) block=(256,1,1) lds=65536
.amdgcn_target "amdgcn-amd-amdhsa--gfx950"
.text
.globl prep_kernel
.p2align 8
.type prep_kernel,@function
prep_kernel:
    s_load_dwordx16 s[4:19], s[0:1], 0
    s_load_dwordx8 s[20:27], s[0:1], 64
    s_load_dwordx4 s[28:31], s[0:1], 96
    s_load_dwordx2 s[32:33], s[0:1], 112
    s_waitcnt lgkmcnt(0)
    s_cmp_lt_u32 s2, 448
    s_cbranch_scc1 P_KGEN
    s_cmp_lt_u32 s2, 512
    s_cbranch_scc1 P_LN
    s_cmp_lt_u32 s2, 904
    s_cbranch_scc1 P_T1
    s_cmp_lt_u32 s2, 1296
    s_cbranch_scc1 P_T2
    s_endpgm
P_KGEN:
    s_mov_b32 s36, s6
    s_mov_b32 s37, s7
    s_mov_b32 s38, 0x38000
    s_mov_b32 s39, 0x00020000
    s_mov_b32 s40, s8
    s_mov_b32 s41, s9
    s_mov_b32 s42, 0x38000
    s_mov_b32 s43, 0x00020000
    s_mov_b32 s44, s10
    s_mov_b32 s45, s11
    s_mov_b32 s46, 0x38000
    s_mov_b32 s47, 0x00020000
    s_mov_b32 s48, s12
    s_mov_b32 s49, s13
    s_mov_b32 s50, 0x38000
    s_mov_b32 s51, 0x00020000
    s_mov_b32 s52, s14
    s_mov_b32 s53, s15
    s_mov_b32 s54, 0x380
    s_mov_b32 s55, 0x00020000
    s_add_u32 s56, s32, 0x800000
    s_addc_u32 s57, s33, 0
    s_mov_b32 s58, 0x1c0000
    s_mov_b32 s59, 0x00020000
    v_and_b32 v1, 63, v0
    v_lshrrev_b32 v2, 6, v0
    s_nop 0
    v_readfirstlane_b32 s60, v2
    v_mov_b32 v3, 0
    s_lshl_b32 s61, s2, 1
    buffer_load_ushort v4, v3, s[52:55], s61 offen
    s_lshl_b32 s62, 1, s60
    s_lshl_b32 s63, 16, s60
    s_lshl_b32 s64, 128, s60
    s_cmp_eq_u32 s60, 0
    s_cselect_b32 s64, 0, s64
    v_cvt_f32_u32 v5, s62
    v_cvt_f32_u32 v6, s63
    v_cvt_f32_u32 v7, s64
    v_lshrrev_b32 v8, 4, v1
    v_mul_u32_u24 v8, 1088, v8
    v_and_b32 v9, 3, v1
    v_mul_u32_u24 v9, 272, v9
    v_add_u32 v8, v8, v9
    v_bfe_u32 v9, v1, 2, 2
    v_lshlrev_b32 v9, 2, v9
    v_add_u32 v8, v8, v9
    v_mul_u32_u24 v9, 17408, v2
    v_add_u32 v8, v8, v9
    v_lshrrev_b32 v10, 4, v1
    v_mul_u32_u24 v10, 272, v10
    v_and_b32 v11, 15, v1
    v_lshlrev_b32 v11, 4, v11
    v_add_u32 v10, v10, v11
    v_add_u32 v10, v10, v9
    s_waitcnt vmcnt(0)
    v_lshlrev_b32 v4, 16, v4
    v_mul_f32 v4, 0x3fb8aa3b, v4
    v_exp_f32 v4, v4
    s_nop 0
    v_cvt_pk_bf16_f32 v4, v4, v4
    v_lshlrev_b32 v4, 16, v4
    v_mov_b32 v12, 0
    v_mov_b32 v13, 0
    v_mov_b32 v14, 0
    v_mov_b32 v15, 0
    s_lshl_b32 s61, s2, 9
    v_lshlrev_b32 v11, 1, v1
    buffer_load_ushort v64, v11, s[36:39], s61 offen offset:0
    buffer_load_ushort v65, v11, s[40:43], s61 offen offset:0
    buffer_load_ushort v66, v11, s[44:47], s61 offen offset:0
    buffer_load_ushort v67, v11, s[48:51], s61 offen offset:0
    buffer_load_ushort v68, v11, s[36:39], s61 offen offset:128
    buffer_load_ushort v69, v11, s[40:43], s61 offen offset:128
    buffer_load_ushort v70, v11, s[44:47], s61 offen offset:128
    buffer_load_ushort v71, v11, s[48:51], s61 offen offset:128
    buffer_load_ushort v72, v11, s[36:39], s61 offen offset:256
    buffer_load_ushort v73, v11, s[40:43], s61 offen offset:256
    buffer_load_ushort v74, v11, s[44:47], s61 offen offset:256
    buffer_load_ushort v75, v11, s[48:51], s61 offen offset:256
    buffer_load_ushort v76, v11, s[36:39], s61 offen offset:384
    buffer_load_ushort v77, v11, s[40:43], s61 offen offset:384
    buffer_load_ushort v78, v11, s[44:47], s61 offen offset:384
    buffer_load_ushort v79, v11, s[48:51], s61 offen offset:384
    s_waitcnt vmcnt(0)
    v_lshlrev_b32 v16, 16, v64
    v_lshlrev_b32 v17, 16, v65
    v_lshlrev_b32 v18, 16, v66
    v_lshlrev_b32 v19, 16, v67
    v_mul_f32 v16, 0x3fb8aa3b, v16
    v_exp_f32 v16, v16
    s_nop 0
    v_cvt_pk_bf16_f32 v16, v16, v16
    v_lshlrev_b32 v16, 16, v16
    v_mul_f32 v20, v16, v4
    v_sub_f32 v20, 0, v20
    v_mul_f32 v21, v17, v4
    v_mul_f32 v18, v18, v4
    v_mul_f32 v19, v19, v4
    v_mul_f32 v30, v20, v5
    v_mul_f32 v30, 0x3fb8aa3b, v30
    v_exp_f32 v30, v30
    v_mul_f32 v31, v21, v5
    v_mul_f32 v31, 0x3e22f983, v31
    v_fract_f32 v31, v31
    v_cos_f32 v22, v31
    v_sin_f32 v23, v31
    s_nop 0
    v_mul_f32 v22, v30, v22
    v_mul_f32 v23, v30, v23
    v_mul_f32 v30, v20, v6
    v_mul_f32 v30, 0x3fb8aa3b, v30
    v_exp_f32 v30, v30
    v_mul_f32 v31, v21, v6
    v_mul_f32 v31, 0x3e22f983, v31
    v_fract_f32 v31, v31
    v_cos_f32 v24, v31
    v_sin_f32 v25, v31
    s_nop 0
    v_mul_f32 v24, v30, v24
    v_mul_f32 v25, v30, v25
    v_mul_f32 v30, v20, v7
    v_mul_f32 v30, 0x3fb8aa3b, v30
    v_exp_f32 v30, v30
    v_mul_f32 v31, v21, v7
    v_mul_f32 v31, 0x3e22f983, v31
    v_fract_f32 v31, v31
    v_cos_f32 v26, v31
    v_sin_f32 v27, v31
    s_nop 0
    v_mul_f32 v26, v30, v26
    v_mul_f32 v27, v30, v27
    v_mul_f32 v30, v26, v18
    v_fma_f32 v30, -v27, v19, v30
    v_mul_f32 v27, v27, v18
    v_fma_f32 v27, v26, v19, v27
    v_mov_b32 v26, v30
    v_mov_b32 v28, 1.0
    v_mov_b32 v29, 0
    ds_write_b32 v8, v26 offset:0
    v_sub_f32 v31, 0, v27
    ds_write_b32 v8, v31 offset:4352
    ds_write_b32 v8, v28 offset:8704
    ds_write_b32 v8, v29 offset:13056
    v_mul_f32 v30, v26, v24
    v_fma_f32 v30, -v27, v25, v30
    v_mul_f32 v27, v27, v24
    v_fma_f32 v27, v26, v25, v27
    v_mov_b32 v26, v30
    v_mul_f32 v30, v28, v22
    v_fma_f32 v30, -v29, v23, v30
    v_mul_f32 v29, v29, v22
    v_fma_f32 v29, v28, v23, v29
    v_mov_b32 v28, v30
    ds_write_b32 v8, v26 offset:16
    v_sub_f32 v31, 0, v27
    ds_write_b32 v8, v31 offset:4368
    ds_write_b32 v8, v28 offset:8720
    ds_write_b32 v8, v29 offset:13072
    v_mul_f32 v30, v26, v24
    v_fma_f32 v30, -v27, v25, v30
    v_mul_f32 v27, v27, v24
    v_fma_f32 v27, v26, v25, v27
    v_mov_b32 v26, v30
    v_mul_f32 v30, v28, v22
    v_fma_f32 v30, -v29, v23, v30
    v_mul_f32 v29, v29, v22
    v_fma_f32 v29, v28, v23, v29
    v_mov_b32 v28, v30
    ds_write_b32 v8, v26 offset:32
    v_sub_f32 v31, 0, v27
    ds_write_b32 v8, v31 offset:4384
    ds_write_b32 v8, v28 offset:8736
    ds_write_b32 v8, v29 offset:13088
    v_mul_f32 v30, v26, v24
    v_fma_f32 v30, -v27, v25, v30
    v_mul_f32 v27, v27, v24
    v_fma_f32 v27, v26, v25, v27
    v_mov_b32 v26, v30
    v_mul_f32 v30, v28, v22
    v_fma_f32 v30, -v29, v23, v30
    v_mul_f32 v29, v29, v22
    v_fma_f32 v29, v28, v23, v29
    v_mov_b32 v28, v30
    ds_write_b32 v8, v26 offset:48
    v_sub_f32 v31, 0, v27
    ds_write_b32 v8, v31 offset:4400
    ds_write_b32 v8, v28 offset:8752
    ds_write_b32 v8, v29 offset:13104
    v_mul_f32 v30, v26, v24
    v_fma_f32 v30, -v27, v25, v30
    v_mul_f32 v27, v27, v24
    v_fma_f32 v27, v26, v25, v27
    v_mov_b32 v26, v30
    v_mul_f32 v30, v28, v22
    v_fma_f32 v30, -v29, v23, v30
    v_mul_f32 v29, v29, v22
    v_fma_f32 v29, v28, v23, v29
    v_mov_b32 v28, v30
    ds_write_b32 v8, v26 offset:64
    v_sub_f32 v31, 0, v27
    ds_write_b32 v8, v31 offset:4416
    ds_write_b32 v8, v28 offset:8768
    ds_write_b32 v8, v29 offset:13120
    v_mul_f32 v30, v26, v24
    v_fma_f32 v30, -v27, v25, v30
    v_mul_f32 v27, v27, v24
    v_fma_f32 v27, v26, v25, v27
    v_mov_b32 v26, v30
    v_mul_f32 v30, v28, v22
    v_fma_f32 v30, -v29, v23, v30
    v_mul_f32 v29, v29, v22
    v_fma_f32 v29, v28, v23, v29
    v_mov_b32 v28, v30
    ds_write_b32 v8, v26 offset:80
    v_sub_f32 v31, 0, v27
    ds_write_b32 v8, v31 offset:4432
    ds_write_b32 v8, v28 offset:8784
    ds_write_b32 v8, v29 offset:13136
    v_mul_f32 v30, v26, v24
    v_fma_f32 v30, -v27, v25, v30
    v_mul_f32 v27, v27, v24
    v_fma_f32 v27, v26, v25, v27
    v_mov_b32 v26, v30
    v_mul_f32 v30, v28, v22
    v_fma_f32 v30, -v29, v23, v30
    v_mul_f32 v29, v29, v22
    v_fma_f32 v29, v28, v23, v29
    v_mov_b32 v28, v30
    ds_write_b32 v8, v26 offset:96
    v_sub_f32 v31, 0, v27
    ds_write_b32 v8, v31 offset:4448
    ds_write_b32 v8, v28 offset:8800
    ds_write_b32 v8, v29 offset:13152
    v_mul_f32 v30, v26, v24
    v_fma_f32 v30, -v27, v25, v30
    v_mul_f32 v27, v27, v24
    v_fma_f32 v27, v26, v25, v27
    v_mov_b32 v26, v30
    v_mul_f32 v30, v28, v22
    v_fma_f32 v30, -v29, v23, v30
    v_mul_f32 v29, v29, v22
    v_fma_f32 v29, v28, v23, v29
    v_mov_b32 v28, v30
    ds_write_b32 v8, v26 offset:112
    v_sub_f32 v31, 0, v27
    ds_write_b32 v8, v31 offset:4464
    ds_write_b32 v8, v28 offset:8816
    ds_write_b32 v8, v29 offset:13168
    v_mul_f32 v30, v26, v24
    v_fma_f32 v30, -v27, v25, v30
    v_mul_f32 v27, v27, v24
    v_fma_f32 v27, v26, v25, v27
    v_mov_b32 v26, v30
    v_mul_f32 v30, v28, v22
    v_fma_f32 v30, -v29, v23, v30
    v_mul_f32 v29, v29, v22
    v_fma_f32 v29, v28, v23, v29
    v_mov_b32 v28, v30
    ds_write_b32 v8, v26 offset:128
    v_sub_f32 v31, 0, v27
    ds_write_b32 v8, v31 offset:4480
    ds_write_b32 v8, v28 offset:8832
    ds_write_b32 v8, v29 offset:13184
    v_mul_f32 v30, v26, v24
    v_fma_f32 v30, -v27, v25, v30
    v_mul_f32 v27, v27, v24
    v_fma_f32 v27, v26, v25, v27
    v_mov_b32 v26, v30
    v_mul_f32 v30, v28, v22
    v_fma_f32 v30, -v29, v23, v30
    v_mul_f32 v29, v29, v22
    v_fma_f32 v29, v28, v23, v29
    v_mov_b32 v28, v30
    ds_write_b32 v8, v26 offset:144
    v_sub_f32 v31, 0, v27
    ds_write_b32 v8, v31 offset:4496
    ds_write_b32 v8, v28 offset:8848
    ds_write_b32 v8, v29 offset:13200
    v_mul_f32 v30, v26, v24
    v_fma_f32 v30, -v27, v25, v30
    v_mul_f32 v27, v27, v24
    v_fma_f32 v27, v26, v25, v27
    v_mov_b32 v26, v30
    v_mul_f32 v30, v28, v22
    v_fma_f32 v30, -v29, v23, v30
    v_mul_f32 v29, v29, v22
    v_fma_f32 v29, v28, v23, v29
    v_mov_b32 v28, v30
    ds_write_b32 v8, v26 offset:160
    v_sub_f32 v31, 0, v27
    ds_write_b32 v8, v31 offset:4512
    ds_write_b32 v8, v28 offset:8864
    ds_write_b32 v8, v29 offset:13216
    v_mul_f32 v30, v26, v24
    v_fma_f32 v30, -v27, v25, v30
    v_mul_f32 v27, v27, v24
    v_fma_f32 v27, v26, v25, v27
    v_mov_b32 v26, v30
    v_mul_f32 v30, v28, v22
    v_fma_f32 v30, -v29, v23, v30
    v_mul_f32 v29, v29, v22
    v_fma_f32 v29, v28, v23, v29
    v_mov_b32 v28, v30
    ds_write_b32 v8, v26 offset:176
    v_sub_f32 v31, 0, v27
    ds_write_b32 v8, v31 offset:4528
    ds_write_b32 v8, v28 offset:8880
    ds_write_b32 v8, v29 offset:13232
    v_mul_f32 v30, v26, v24
    v_fma_f32 v30, -v27, v25, v30
    v_mul_f32 v27, v27, v24
    v_fma_f32 v27, v26, v25, v27
    v_mov_b32 v26, v30
    v_mul_f32 v30, v28, v22
    v_fma_f32 v30, -v29, v23, v30
    v_mul_f32 v29, v29, v22
    v_fma_f32 v29, v28, v23, v29
    v_mov_b32 v28, v30
    ds_write_b32 v8, v26 offset:192
    v_sub_f32 v31, 0, v27
    ds_write_b32 v8, v31 offset:4544
    ds_write_b32 v8, v28 offset:8896
    ds_write_b32 v8, v29 offset:13248
    v_mul_f32 v30, v26, v24
    v_fma_f32 v30, -v27, v25, v30
    v_mul_f32 v27, v27, v24
    v_fma_f32 v27, v26, v25, v27
    v_mov_b32 v26, v30
    v_mul_f32 v30, v28, v22
    v_fma_f32 v30, -v29, v23, v30
    v_mul_f32 v29, v29, v22
    v_fma_f32 v29, v28, v23, v29
    v_mov_b32 v28, v30
    ds_write_b32 v8, v26 offset:208
    v_sub_f32 v31, 0, v27
    ds_write_b32 v8, v31 offset:4560
    ds_write_b32 v8, v28 offset:8912
    ds_write_b32 v8, v29 offset:13264
    v_mul_f32 v30, v26, v24
    v_fma_f32 v30, -v27, v25, v30
    v_mul_f32 v27, v27, v24
    v_fma_f32 v27, v26, v25, v27
    v_mov_b32 v26, v30
    v_mul_f32 v30, v28, v22
    v_fma_f32 v30, -v29, v23, v30
    v_mul_f32 v29, v29, v22
    v_fma_f32 v29, v28, v23, v29
    v_mov_b32 v28, v30
    ds_write_b32 v8, v26 offset:224
    v_sub_f32 v31, 0, v27
    ds_write_b32 v8, v31 offset:4576
    ds_write_b32 v8, v28 offset:8928
    ds_write_b32 v8, v29 offset:13280
    v_mul_f32 v30, v26, v24
    v_fma_f32 v30, -v27, v25, v30
    v_mul_f32 v27, v27, v24
    v_fma_f32 v27, v26, v25, v27
    v_mov_b32 v26, v30
    v_mul_f32 v30, v28, v22
    v_fma_f32 v30, -v29, v23, v30
    v_mul_f32 v29, v29, v22
    v_fma_f32 v29, v28, v23, v29
    v_mov_b32 v28, v30
    ds_write_b32 v8, v26 offset:240
    v_sub_f32 v31, 0, v27
    ds_write_b32 v8, v31 offset:4592
    ds_write_b32 v8, v28 offset:8944
    ds_write_b32 v8, v29 offset:13296
    s_waitcnt lgkmcnt(0)
    ds_read_b128 v[32:35], v10 offset:0
    ds_read_b128 v[36:39], v10 offset:4352
    ds_read_b128 v[40:43], v10 offset:8704
    ds_read_b128 v[44:47], v10 offset:13056
    s_waitcnt lgkmcnt(0)
    v_mfma_f32_16x16x4_f32 v[12:15], v32, v40, v[12:15]
    v_mfma_f32_16x16x4_f32 v[12:15], v36, v44, v[12:15]
    v_mfma_f32_16x16x4_f32 v[12:15], v33, v41, v[12:15]
    v_mfma_f32_16x16x4_f32 v[12:15], v37, v45, v[12:15]
    v_mfma_f32_16x16x4_f32 v[12:15], v34, v42, v[12:15]
    v_mfma_f32_16x16x4_f32 v[12:15], v38, v46, v[12:15]
    v_mfma_f32_16x16x4_f32 v[12:15], v35, v43, v[12:15]
    v_mfma_f32_16x16x4_f32 v[12:15], v39, v47, v[12:15]
    ds_read_b128 v[32:35], v10 offset:1088
    ds_read_b128 v[36:39], v10 offset:5440
    ds_read_b128 v[40:43], v10 offset:9792
    ds_read_b128 v[44:47], v10 offset:14144
    s_waitcnt lgkmcnt(0)
    v_mfma_f32_16x16x4_f32 v[12:15], v32, v40, v[12:15]
    v_mfma_f32_16x16x4_f32 v[12:15], v36, v44, v[12:15]
    v_mfma_f32_16x16x4_f32 v[12:15], v33, v41, v[12:15]
    v_mfma_f32_16x16x4_f32 v[12:15], v37, v45, v[12:15]
    v_mfma_f32_16x16x4_f32 v[12:15], v34, v42, v[12:15]
    v_mfma_f32_16x16x4_f32 v[12:15], v38, v46, v[12:15]
    v_mfma_f32_16x16x4_f32 v[12:15], v35, v43, v[12:15]
    v_mfma_f32_16x16x4_f32 v[12:15], v39, v47, v[12:15]
    ds_read_b128 v[32:35], v10 offset:2176
    ds_read_b128 v[36:39], v10 offset:6528
    ds_read_b128 v[40:43], v10 offset:10880
    ds_read_b128 v[44:47], v10 offset:15232
    s_waitcnt lgkmcnt(0)
    v_mfma_f32_16x16x4_f32 v[12:15], v32, v40, v[12:15]
    v_mfma_f32_16x16x4_f32 v[12:15], v36, v44, v[12:15]
    v_mfma_f32_16x16x4_f32 v[12:15], v33, v41, v[12:15]
    v_mfma_f32_16x16x4_f32 v[12:15], v37, v45, v[12:15]
    v_mfma_f32_16x16x4_f32 v[12:15], v34, v42, v[12:15]
    v_mfma_f32_16x16x4_f32 v[12:15], v38, v46, v[12:15]
    v_mfma_f32_16x16x4_f32 v[12:15], v35, v43, v[12:15]
    v_mfma_f32_16x16x4_f32 v[12:15], v39, v47, v[12:15]
    ds_read_b128 v[32:35], v10 offset:3264
    ds_read_b128 v[36:39], v10 offset:7616
    ds_read_b128 v[40:43], v10 offset:11968
    ds_read_b128 v[44:47], v10 offset:16320
    s_waitcnt lgkmcnt(0)
    v_mfma_f32_16x16x4_f32 v[12:15], v32, v40, v[12:15]
    v_mfma_f32_16x16x4_f32 v[12:15], v36, v44, v[12:15]
    v_mfma_f32_16x16x4_f32 v[12:15], v33, v41, v[12:15]
    v_mfma_f32_16x16x4_f32 v[12:15], v37, v45, v[12:15]
    v_mfma_f32_16x16x4_f32 v[12:15], v34, v42, v[12:15]
    v_mfma_f32_16x16x4_f32 v[12:15], v38, v46, v[12:15]
    v_mfma_f32_16x16x4_f32 v[12:15], v35, v43, v[12:15]
    v_mfma_f32_16x16x4_f32 v[12:15], v39, v47, v[12:15]
    v_lshlrev_b32 v16, 16, v68
    v_lshlrev_b32 v17, 16, v69
    v_lshlrev_b32 v18, 16, v70
    v_lshlrev_b32 v19, 16, v71
    v_mul_f32 v16, 0x3fb8aa3b, v16
    v_exp_f32 v16, v16
    s_nop 0
    v_cvt_pk_bf16_f32 v16, v16, v16
    v_lshlrev_b32 v16, 16, v16
    v_mul_f32 v20, v16, v4
    v_sub_f32 v20, 0, v20
    v_mul_f32 v21, v17, v4
    v_mul_f32 v18, v18, v4
    v_mul_f32 v19, v19, v4
    v_mul_f32 v30, v20, v5
    v_mul_f32 v30, 0x3fb8aa3b, v30
    v_exp_f32 v30, v30
    v_mul_f32 v31, v21, v5
    v_mul_f32 v31, 0x3e22f983, v31
    v_fract_f32 v31, v31
    v_cos_f32 v22, v31
    v_sin_f32 v23, v31
    s_nop 0
    v_mul_f32 v22, v30, v22
    v_mul_f32 v23, v30, v23
    v_mul_f32 v30, v20, v6
    v_mul_f32 v30, 0x3fb8aa3b, v30
    v_exp_f32 v30, v30
    v_mul_f32 v31, v21, v6
    v_mul_f32 v31, 0x3e22f983, v31
    v_fract_f32 v31, v31
    v_cos_f32 v24, v31
    v_sin_f32 v25, v31
    s_nop 0
    v_mul_f32 v24, v30, v24
    v_mul_f32 v25, v30, v25
    v_mul_f32 v30, v20, v7
    v_mul_f32 v30, 0x3fb8aa3b, v30
    v_exp_f32 v30, v30
    v_mul_f32 v31, v21, v7
    v_mul_f32 v31, 0x3e22f983, v31
    v_fract_f32 v31, v31
    v_cos_f32 v26, v31
    v_sin_f32 v27, v31
    s_nop 0
    v_mul_f32 v26, v30, v26
    v_mul_f32 v27, v30, v27
    v_mul_f32 v30, v26, v18
    v_fma_f32 v30, -v27, v19, v30
    v_mul_f32 v27, v27, v18
    v_fma_f32 v27, v26, v19, v27
    v_mov_b32 v26, v30
    v_mov_b32 v28, 1.0
    v_mov_b32 v29, 0
    ds_write_b32 v8, v26 offset:0
    v_sub_f32 v31, 0, v27
    ds_write_b32 v8, v31 offset:4352
    ds_write_b32 v8, v28 offset:8704
    ds_write_b32 v8, v29 offset:13056
    v_mul_f32 v30, v26, v24
    v_fma_f32 v30, -v27, v25, v30
    v_mul_f32 v27, v27, v24
    v_fma_f32 v27, v26, v25, v27
    v_mov_b32 v26, v30
    v_mul_f32 v30, v28, v22
    v_fma_f32 v30, -v29, v23, v30
    v_mul_f32 v29, v29, v22
    v_fma_f32 v29, v28, v23, v29
    v_mov_b32 v28, v30
    ds_write_b32 v8, v26 offset:16
    v_sub_f32 v31, 0, v27
    ds_write_b32 v8, v31 offset:4368
    ds_write_b32 v8, v28 offset:8720
    ds_write_b32 v8, v29 offset:13072
    v_mul_f32 v30, v26, v24
    v_fma_f32 v30, -v27, v25, v30
    v_mul_f32 v27, v27, v24
    v_fma_f32 v27, v26, v25, v27
    v_mov_b32 v26, v30
    v_mul_f32 v30, v28, v22
    v_fma_f32 v30, -v29, v23, v30
    v_mul_f32 v29, v29, v22
    v_fma_f32 v29, v28, v23, v29
    v_mov_b32 v28, v30
    ds_write_b32 v8, v26 offset:32
    v_sub_f32 v31, 0, v27
    ds_write_b32 v8, v31 offset:4384
    ds_write_b32 v8, v28 offset:8736
    ds_write_b32 v8, v29 offset:13088
    v_mul_f32 v30, v26, v24
    v_fma_f32 v30, -v27, v25, v30
    v_mul_f32 v27, v27, v24
    v_fma_f32 v27, v26, v25, v27
    v_mov_b32 v26, v30
    v_mul_f32 v30, v28, v22
    v_fma_f32 v30, -v29, v23, v30
    v_mul_f32 v29, v29, v22
    v_fma_f32 v29, v28, v23, v29
    v_mov_b32 v28, v30
    ds_write_b32 v8, v26 offset:48
    v_sub_f32 v31, 0, v27
    ds_write_b32 v8, v31 offset:4400
    ds_write_b32 v8, v28 offset:8752
    ds_write_b32 v8, v29 offset:13104
    v_mul_f32 v30, v26, v24
    v_fma_f32 v30, -v27, v25, v30
    v_mul_f32 v27, v27, v24
    v_fma_f32 v27, v26, v25, v27
    v_mov_b32 v26, v30
    v_mul_f32 v30, v28, v22
    v_fma_f32 v30, -v29, v23, v30
    v_mul_f32 v29, v29, v22
    v_fma_f32 v29, v28, v23, v29
    v_mov_b32 v28, v30
    ds_write_b32 v8, v26 offset:64
    v_sub_f32 v31, 0, v27
    ds_write_b32 v8, v31 offset:4416
    ds_write_b32 v8, v28 offset:8768
    ds_write_b32 v8, v29 offset:13120
    v_mul_f32 v30, v26, v24
    v_fma_f32 v30, -v27, v25, v30
    v_mul_f32 v27, v27, v24
    v_fma_f32 v27, v26, v25, v27
    v_mov_b32 v26, v30
    v_mul_f32 v30, v28, v22
    v_fma_f32 v30, -v29, v23, v30
    v_mul_f32 v29, v29, v22
    v_fma_f32 v29, v28, v23, v29
    v_mov_b32 v28, v30
    ds_write_b32 v8, v26 offset:80
    v_sub_f32 v31, 0, v27
    ds_write_b32 v8, v31 offset:4432
    ds_write_b32 v8, v28 offset:8784
    ds_write_b32 v8, v29 offset:13136
    v_mul_f32 v30, v26, v24
    v_fma_f32 v30, -v27, v25, v30
    v_mul_f32 v27, v27, v24
    v_fma_f32 v27, v26, v25, v27
    v_mov_b32 v26, v30
    v_mul_f32 v30, v28, v22
    v_fma_f32 v30, -v29, v23, v30
    v_mul_f32 v29, v29, v22
    v_fma_f32 v29, v28, v23, v29
    v_mov_b32 v28, v30
    ds_write_b32 v8, v26 offset:96
    v_sub_f32 v31, 0, v27
    ds_write_b32 v8, v31 offset:4448
    ds_write_b32 v8, v28 offset:8800
    ds_write_b32 v8, v29 offset:13152
    v_mul_f32 v30, v26, v24
    v_fma_f32 v30, -v27, v25, v30
    v_mul_f32 v27, v27, v24
    v_fma_f32 v27, v26, v25, v27
    v_mov_b32 v26, v30
    v_mul_f32 v30, v28, v22
    v_fma_f32 v30, -v29, v23, v30
    v_mul_f32 v29, v29, v22
    v_fma_f32 v29, v28, v23, v29
    v_mov_b32 v28, v30
    ds_write_b32 v8, v26 offset:112
    v_sub_f32 v31, 0, v27
    ds_write_b32 v8, v31 offset:4464
    ds_write_b32 v8, v28 offset:8816
    ds_write_b32 v8, v29 offset:13168
    v_mul_f32 v30, v26, v24
    v_fma_f32 v30, -v27, v25, v30
    v_mul_f32 v27, v27, v24
    v_fma_f32 v27, v26, v25, v27
    v_mov_b32 v26, v30
    v_mul_f32 v30, v28, v22
    v_fma_f32 v30, -v29, v23, v30
    v_mul_f32 v29, v29, v22
    v_fma_f32 v29, v28, v23, v29
    v_mov_b32 v28, v30
    ds_write_b32 v8, v26 offset:128
    v_sub_f32 v31, 0, v27
    ds_write_b32 v8, v31 offset:4480
    ds_write_b32 v8, v28 offset:8832
    ds_write_b32 v8, v29 offset:13184
    v_mul_f32 v30, v26, v24
    v_fma_f32 v30, -v27, v25, v30
    v_mul_f32 v27, v27, v24
    v_fma_f32 v27, v26, v25, v27
    v_mov_b32 v26, v30
    v_mul_f32 v30, v28, v22
    v_fma_f32 v30, -v29, v23, v30
    v_mul_f32 v29, v29, v22
    v_fma_f32 v29, v28, v23, v29
    v_mov_b32 v28, v30
    ds_write_b32 v8, v26 offset:144
    v_sub_f32 v31, 0, v27
    ds_write_b32 v8, v31 offset:4496
    ds_write_b32 v8, v28 offset:8848
    ds_write_b32 v8, v29 offset:13200
    v_mul_f32 v30, v26, v24
    v_fma_f32 v30, -v27, v25, v30
    v_mul_f32 v27, v27, v24
    v_fma_f32 v27, v26, v25, v27
    v_mov_b32 v26, v30
    v_mul_f32 v30, v28, v22
    v_fma_f32 v30, -v29, v23, v30
    v_mul_f32 v29, v29, v22
    v_fma_f32 v29, v28, v23, v29
    v_mov_b32 v28, v30
    ds_write_b32 v8, v26 offset:160
    v_sub_f32 v31, 0, v27
    ds_write_b32 v8, v31 offset:4512
    ds_write_b32 v8, v28 offset:8864
    ds_write_b32 v8, v29 offset:13216
    v_mul_f32 v30, v26, v24
    v_fma_f32 v30, -v27, v25, v30
    v_mul_f32 v27, v27, v24
    v_fma_f32 v27, v26, v25, v27
    v_mov_b32 v26, v30
    v_mul_f32 v30, v28, v22
    v_fma_f32 v30, -v29, v23, v30
    v_mul_f32 v29, v29, v22
    v_fma_f32 v29, v28, v23, v29
    v_mov_b32 v28, v30
    ds_write_b32 v8, v26 offset:176
    v_sub_f32 v31, 0, v27
    ds_write_b32 v8, v31 offset:4528
    ds_write_b32 v8, v28 offset:8880
    ds_write_b32 v8, v29 offset:13232
    v_mul_f32 v30, v26, v24
    v_fma_f32 v30, -v27, v25, v30
    v_mul_f32 v27, v27, v24
    v_fma_f32 v27, v26, v25, v27
    v_mov_b32 v26, v30
    v_mul_f32 v30, v28, v22
    v_fma_f32 v30, -v29, v23, v30
    v_mul_f32 v29, v29, v22
    v_fma_f32 v29, v28, v23, v29
    v_mov_b32 v28, v30
    ds_write_b32 v8, v26 offset:192
    v_sub_f32 v31, 0, v27
    ds_write_b32 v8, v31 offset:4544
    ds_write_b32 v8, v28 offset:8896
    ds_write_b32 v8, v29 offset:13248
    v_mul_f32 v30, v26, v24
    v_fma_f32 v30, -v27, v25, v30
    v_mul_f32 v27, v27, v24
    v_fma_f32 v27, v26, v25, v27
    v_mov_b32 v26, v30
    v_mul_f32 v30, v28, v22
    v_fma_f32 v30, -v29, v23, v30
    v_mul_f32 v29, v29, v22
    v_fma_f32 v29, v28, v23, v29
    v_mov_b32 v28, v30
    ds_write_b32 v8, v26 offset:208
    v_sub_f32 v31, 0, v27
    ds_write_b32 v8, v31 offset:4560
    ds_write_b32 v8, v28 offset:8912
    ds_write_b32 v8, v29 offset:13264
    v_mul_f32 v30, v26, v24
    v_fma_f32 v30, -v27, v25, v30
    v_mul_f32 v27, v27, v24
    v_fma_f32 v27, v26, v25, v27
    v_mov_b32 v26, v30
    v_mul_f32 v30, v28, v22
    v_fma_f32 v30, -v29, v23, v30
    v_mul_f32 v29, v29, v22
    v_fma_f32 v29, v28, v23, v29
    v_mov_b32 v28, v30
    ds_write_b32 v8, v26 offset:224
    v_sub_f32 v31, 0, v27
    ds_write_b32 v8, v31 offset:4576
    ds_write_b32 v8, v28 offset:8928
    ds_write_b32 v8, v29 offset:13280
    v_mul_f32 v30, v26, v24
    v_fma_f32 v30, -v27, v25, v30
    v_mul_f32 v27, v27, v24
    v_fma_f32 v27, v26, v25, v27
    v_mov_b32 v26, v30
    v_mul_f32 v30, v28, v22
    v_fma_f32 v30, -v29, v23, v30
    v_mul_f32 v29, v29, v22
    v_fma_f32 v29, v28, v23, v29
    v_mov_b32 v28, v30
    ds_write_b32 v8, v26 offset:240
    v_sub_f32 v31, 0, v27
    ds_write_b32 v8, v31 offset:4592
    ds_write_b32 v8, v28 offset:8944
    ds_write_b32 v8, v29 offset:13296
    s_waitcnt lgkmcnt(0)
    ds_read_b128 v[32:35], v10 offset:0
    ds_read_b128 v[36:39], v10 offset:4352
    ds_read_b128 v[40:43], v10 offset:8704
    ds_read_b128 v[44:47], v10 offset:13056
    s_waitcnt lgkmcnt(0)
    v_mfma_f32_16x16x4_f32 v[12:15], v32, v40, v[12:15]
    v_mfma_f32_16x16x4_f32 v[12:15], v36, v44, v[12:15]
    v_mfma_f32_16x16x4_f32 v[12:15], v33, v41, v[12:15]
    v_mfma_f32_16x16x4_f32 v[12:15], v37, v45, v[12:15]
    v_mfma_f32_16x16x4_f32 v[12:15], v34, v42, v[12:15]
    v_mfma_f32_16x16x4_f32 v[12:15], v38, v46, v[12:15]
    v_mfma_f32_16x16x4_f32 v[12:15], v35, v43, v[12:15]
    v_mfma_f32_16x16x4_f32 v[12:15], v39, v47, v[12:15]
    ds_read_b128 v[32:35], v10 offset:1088
    ds_read_b128 v[36:39], v10 offset:5440
    ds_read_b128 v[40:43], v10 offset:9792
    ds_read_b128 v[44:47], v10 offset:14144
    s_waitcnt lgkmcnt(0)
    v_mfma_f32_16x16x4_f32 v[12:15], v32, v40, v[12:15]
    v_mfma_f32_16x16x4_f32 v[12:15], v36, v44, v[12:15]
    v_mfma_f32_16x16x4_f32 v[12:15], v33, v41, v[12:15]
    v_mfma_f32_16x16x4_f32 v[12:15], v37, v45, v[12:15]
    v_mfma_f32_16x16x4_f32 v[12:15], v34, v42, v[12:15]
    v_mfma_f32_16x16x4_f32 v[12:15], v38, v46, v[12:15]
    v_mfma_f32_16x16x4_f32 v[12:15], v35, v43, v[12:15]
    v_mfma_f32_16x16x4_f32 v[12:15], v39, v47, v[12:15]
    ds_read_b128 v[32:35], v10 offset:2176
    ds_read_b128 v[36:39], v10 offset:6528
    ds_read_b128 v[40:43], v10 offset:10880
    ds_read_b128 v[44:47], v10 offset:15232
    s_waitcnt lgkmcnt(0)
    v_mfma_f32_16x16x4_f32 v[12:15], v32, v40, v[12:15]
    v_mfma_f32_16x16x4_f32 v[12:15], v36, v44, v[12:15]
    v_mfma_f32_16x16x4_f32 v[12:15], v33, v41, v[12:15]
    v_mfma_f32_16x16x4_f32 v[12:15], v37, v45, v[12:15]
    v_mfma_f32_16x16x4_f32 v[12:15], v34, v42, v[12:15]
    v_mfma_f32_16x16x4_f32 v[12:15], v38, v46, v[12:15]
    v_mfma_f32_16x16x4_f32 v[12:15], v35, v43, v[12:15]
    v_mfma_f32_16x16x4_f32 v[12:15], v39, v47, v[12:15]
    ds_read_b128 v[32:35], v10 offset:3264
    ds_read_b128 v[36:39], v10 offset:7616
    ds_read_b128 v[40:43], v10 offset:11968
    ds_read_b128 v[44:47], v10 offset:16320
    s_waitcnt lgkmcnt(0)
    v_mfma_f32_16x16x4_f32 v[12:15], v32, v40, v[12:15]
    v_mfma_f32_16x16x4_f32 v[12:15], v36, v44, v[12:15]
    v_mfma_f32_16x16x4_f32 v[12:15], v33, v41, v[12:15]
    v_mfma_f32_16x16x4_f32 v[12:15], v37, v45, v[12:15]
    v_mfma_f32_16x16x4_f32 v[12:15], v34, v42, v[12:15]
    v_mfma_f32_16x16x4_f32 v[12:15], v38, v46, v[12:15]
    v_mfma_f32_16x16x4_f32 v[12:15], v35, v43, v[12:15]
    v_mfma_f32_16x16x4_f32 v[12:15], v39, v47, v[12:15]
    v_lshlrev_b32 v16, 16, v72
    v_lshlrev_b32 v17, 16, v73
    v_lshlrev_b32 v18, 16, v74
    v_lshlrev_b32 v19, 16, v75
    v_mul_f32 v16, 0x3fb8aa3b, v16
    v_exp_f32 v16, v16
    s_nop 0
    v_cvt_pk_bf16_f32 v16, v16, v16
    v_lshlrev_b32 v16, 16, v16
    v_mul_f32 v20, v16, v4
    v_sub_f32 v20, 0, v20
    v_mul_f32 v21, v17, v4
    v_mul_f32 v18, v18, v4
    v_mul_f32 v19, v19, v4
    v_mul_f32 v30, v20, v5
    v_mul_f32 v30, 0x3fb8aa3b, v30
    v_exp_f32 v30, v30
    v_mul_f32 v31, v21, v5
    v_mul_f32 v31, 0x3e22f983, v31
    v_fract_f32 v31, v31
    v_cos_f32 v22, v31
    v_sin_f32 v23, v31
    s_nop 0
    v_mul_f32 v22, v30, v22
    v_mul_f32 v23, v30, v23
    v_mul_f32 v30, v20, v6
    v_mul_f32 v30, 0x3fb8aa3b, v30
    v_exp_f32 v30, v30
    v_mul_f32 v31, v21, v6
    v_mul_f32 v31, 0x3e22f983, v31
    v_fract_f32 v31, v31
    v_cos_f32 v24, v31
    v_sin_f32 v25, v31
    s_nop 0
    v_mul_f32 v24, v30, v24
    v_mul_f32 v25, v30, v25
    v_mul_f32 v30, v20, v7
    v_mul_f32 v30, 0x3fb8aa3b, v30
    v_exp_f32 v30, v30
    v_mul_f32 v31, v21, v7
    v_mul_f32 v31, 0x3e22f983, v31
    v_fract_f32 v31, v31
    v_cos_f32 v26, v31
    v_sin_f32 v27, v31
    s_nop 0
    v_mul_f32 v26, v30, v26
    v_mul_f32 v27, v30, v27
    v_mul_f32 v30, v26, v18
    v_fma_f32 v30, -v27, v19, v30
    v_mul_f32 v27, v27, v18
    v_fma_f32 v27, v26, v19, v27
    v_mov_b32 v26, v30
    v_mov_b32 v28, 1.0
    v_mov_b32 v29, 0
    ds_write_b32 v8, v26 offset:0
    v_sub_f32 v31, 0, v27
    ds_write_b32 v8, v31 offset:4352
    ds_write_b32 v8, v28 offset:8704
    ds_write_b32 v8, v29 offset:13056
    v_mul_f32 v30, v26, v24
    v_fma_f32 v30, -v27, v25, v30
    v_mul_f32 v27, v27, v24
    v_fma_f32 v27, v26, v25, v27
    v_mov_b32 v26, v30
    v_mul_f32 v30, v28, v22
    v_fma_f32 v30, -v29, v23, v30
    v_mul_f32 v29, v29, v22
    v_fma_f32 v29, v28, v23, v29
    v_mov_b32 v28, v30
    ds_write_b32 v8, v26 offset:16
    v_sub_f32 v31, 0, v27
    ds_write_b32 v8, v31 offset:4368
    ds_write_b32 v8, v28 offset:8720
    ds_write_b32 v8, v29 offset:13072
    v_mul_f32 v30, v26, v24
    v_fma_f32 v30, -v27, v25, v30
    v_mul_f32 v27, v27, v24
    v_fma_f32 v27, v26, v25, v27
    v_mov_b32 v26, v30
    v_mul_f32 v30, v28, v22
    v_fma_f32 v30, -v29, v23, v30
    v_mul_f32 v29, v29, v22
    v_fma_f32 v29, v28, v23, v29
    v_mov_b32 v28, v30
    ds_write_b32 v8, v26 offset:32
    v_sub_f32 v31, 0, v27
    ds_write_b32 v8, v31 offset:4384
    ds_write_b32 v8, v28 offset:8736
    ds_write_b32 v8, v29 offset:13088
    v_mul_f32 v30, v26, v24
    v_fma_f32 v30, -v27, v25, v30
    v_mul_f32 v27, v27, v24
    v_fma_f32 v27, v26, v25, v27
    v_mov_b32 v26, v30
    v_mul_f32 v30, v28, v22
    v_fma_f32 v30, -v29, v23, v30
    v_mul_f32 v29, v29, v22
    v_fma_f32 v29, v28, v23, v29
    v_mov_b32 v28, v30
    ds_write_b32 v8, v26 offset:48
    v_sub_f32 v31, 0, v27
    ds_write_b32 v8, v31 offset:4400
    ds_write_b32 v8, v28 offset:8752
    ds_write_b32 v8, v29 offset:13104
    v_mul_f32 v30, v26, v24
    v_fma_f32 v30, -v27, v25, v30
    v_mul_f32 v27, v27, v24
    v_fma_f32 v27, v26, v25, v27
    v_mov_b32 v26, v30
    v_mul_f32 v30, v28, v22
    v_fma_f32 v30, -v29, v23, v30
    v_mul_f32 v29, v29, v22
    v_fma_f32 v29, v28, v23, v29
    v_mov_b32 v28, v30
    ds_write_b32 v8, v26 offset:64
    v_sub_f32 v31, 0, v27
    ds_write_b32 v8, v31 offset:4416
    ds_write_b32 v8, v28 offset:8768
    ds_write_b32 v8, v29 offset:13120
    v_mul_f32 v30, v26, v24
    v_fma_f32 v30, -v27, v25, v30
    v_mul_f32 v27, v27, v24
    v_fma_f32 v27, v26, v25, v27
    v_mov_b32 v26, v30
    v_mul_f32 v30, v28, v22
    v_fma_f32 v30, -v29, v23, v30
    v_mul_f32 v29, v29, v22
    v_fma_f32 v29, v28, v23, v29
    v_mov_b32 v28, v30
    ds_write_b32 v8, v26 offset:80
    v_sub_f32 v31, 0, v27
    ds_write_b32 v8, v31 offset:4432
    ds_write_b32 v8, v28 offset:8784
    ds_write_b32 v8, v29 offset:13136
    v_mul_f32 v30, v26, v24
    v_fma_f32 v30, -v27, v25, v30
    v_mul_f32 v27, v27, v24
    v_fma_f32 v27, v26, v25, v27
    v_mov_b32 v26, v30
    v_mul_f32 v30, v28, v22
    v_fma_f32 v30, -v29, v23, v30
    v_mul_f32 v29, v29, v22
    v_fma_f32 v29, v28, v23, v29
    v_mov_b32 v28, v30
    ds_write_b32 v8, v26 offset:96
    v_sub_f32 v31, 0, v27
    ds_write_b32 v8, v31 offset:4448
    ds_write_b32 v8, v28 offset:8800
    ds_write_b32 v8, v29 offset:13152
    v_mul_f32 v30, v26, v24
    v_fma_f32 v30, -v27, v25, v30
    v_mul_f32 v27, v27, v24
    v_fma_f32 v27, v26, v25, v27
    v_mov_b32 v26, v30
    v_mul_f32 v30, v28, v22
    v_fma_f32 v30, -v29, v23, v30
    v_mul_f32 v29, v29, v22
    v_fma_f32 v29, v28, v23, v29
    v_mov_b32 v28, v30
    ds_write_b32 v8, v26 offset:112
    v_sub_f32 v31, 0, v27
    ds_write_b32 v8, v31 offset:4464
    ds_write_b32 v8, v28 offset:8816
    ds_write_b32 v8, v29 offset:13168
    v_mul_f32 v30, v26, v24
    v_fma_f32 v30, -v27, v25, v30
    v_mul_f32 v27, v27, v24
    v_fma_f32 v27, v26, v25, v27
    v_mov_b32 v26, v30
    v_mul_f32 v30, v28, v22
    v_fma_f32 v30, -v29, v23, v30
    v_mul_f32 v29, v29, v22
    v_fma_f32 v29, v28, v23, v29
    v_mov_b32 v28, v30
    ds_write_b32 v8, v26 offset:128
    v_sub_f32 v31, 0, v27
    ds_write_b32 v8, v31 offset:4480
    ds_write_b32 v8, v28 offset:8832
    ds_write_b32 v8, v29 offset:13184
    v_mul_f32 v30, v26, v24
    v_fma_f32 v30, -v27, v25, v30
    v_mul_f32 v27, v27, v24
    v_fma_f32 v27, v26, v25, v27
    v_mov_b32 v26, v30
    v_mul_f32 v30, v28, v22
    v_fma_f32 v30, -v29, v23, v30
    v_mul_f32 v29, v29, v22
    v_fma_f32 v29, v28, v23, v29
    v_mov_b32 v28, v30
    ds_write_b32 v8, v26 offset:144
    v_sub_f32 v31, 0, v27
    ds_write_b32 v8, v31 offset:4496
    ds_write_b32 v8, v28 offset:8848
    ds_write_b32 v8, v29 offset:13200
    v_mul_f32 v30, v26, v24
    v_fma_f32 v30, -v27, v25, v30
    v_mul_f32 v27, v27, v24
    v_fma_f32 v27, v26, v25, v27
    v_mov_b32 v26, v30
    v_mul_f32 v30, v28, v22
    v_fma_f32 v30, -v29, v23, v30
    v_mul_f32 v29, v29, v22
    v_fma_f32 v29, v28, v23, v29
    v_mov_b32 v28, v30
    ds_write_b32 v8, v26 offset:160
    v_sub_f32 v31, 0, v27
    ds_write_b32 v8, v31 offset:4512
    ds_write_b32 v8, v28 offset:8864
    ds_write_b32 v8, v29 offset:13216
    v_mul_f32 v30, v26, v24
    v_fma_f32 v30, -v27, v25, v30
    v_mul_f32 v27, v27, v24
    v_fma_f32 v27, v26, v25, v27
    v_mov_b32 v26, v30
    v_mul_f32 v30, v28, v22
    v_fma_f32 v30, -v29, v23, v30
    v_mul_f32 v29, v29, v22
    v_fma_f32 v29, v28, v23, v29
    v_mov_b32 v28, v30
    ds_write_b32 v8, v26 offset:176
    v_sub_f32 v31, 0, v27
    ds_write_b32 v8, v31 offset:4528
    ds_write_b32 v8, v28 offset:8880
    ds_write_b32 v8, v29 offset:13232
    v_mul_f32 v30, v26, v24
    v_fma_f32 v30, -v27, v25, v30
    v_mul_f32 v27, v27, v24
    v_fma_f32 v27, v26, v25, v27
    v_mov_b32 v26, v30
    v_mul_f32 v30, v28, v22
    v_fma_f32 v30, -v29, v23, v30
    v_mul_f32 v29, v29, v22
    v_fma_f32 v29, v28, v23, v29
    v_mov_b32 v28, v30
    ds_write_b32 v8, v26 offset:192
    v_sub_f32 v31, 0, v27
    ds_write_b32 v8, v31 offset:4544
    ds_write_b32 v8, v28 offset:8896
    ds_write_b32 v8, v29 offset:13248
    v_mul_f32 v30, v26, v24
    v_fma_f32 v30, -v27, v25, v30
    v_mul_f32 v27, v27, v24
    v_fma_f32 v27, v26, v25, v27
    v_mov_b32 v26, v30
    v_mul_f32 v30, v28, v22
    v_fma_f32 v30, -v29, v23, v30
    v_mul_f32 v29, v29, v22
    v_fma_f32 v29, v28, v23, v29
    v_mov_b32 v28, v30
    ds_write_b32 v8, v26 offset:208
    v_sub_f32 v31, 0, v27
    ds_write_b32 v8, v31 offset:4560
    ds_write_b32 v8, v28 offset:8912
    ds_write_b32 v8, v29 offset:13264
    v_mul_f32 v30, v26, v24
    v_fma_f32 v30, -v27, v25, v30
    v_mul_f32 v27, v27, v24
    v_fma_f32 v27, v26, v25, v27
    v_mov_b32 v26, v30
    v_mul_f32 v30, v28, v22
    v_fma_f32 v30, -v29, v23, v30
    v_mul_f32 v29, v29, v22
    v_fma_f32 v29, v28, v23, v29
    v_mov_b32 v28, v30
    ds_write_b32 v8, v26 offset:224
    v_sub_f32 v31, 0, v27
    ds_write_b32 v8, v31 offset:4576
    ds_write_b32 v8, v28 offset:8928
    ds_write_b32 v8, v29 offset:13280
    v_mul_f32 v30, v26, v24
    v_fma_f32 v30, -v27, v25, v30
    v_mul_f32 v27, v27, v24
    v_fma_f32 v27, v26, v25, v27
    v_mov_b32 v26, v30
    v_mul_f32 v30, v28, v22
    v_fma_f32 v30, -v29, v23, v30
    v_mul_f32 v29, v29, v22
    v_fma_f32 v29, v28, v23, v29
    v_mov_b32 v28, v30
    ds_write_b32 v8, v26 offset:240
    v_sub_f32 v31, 0, v27
    ds_write_b32 v8, v31 offset:4592
    ds_write_b32 v8, v28 offset:8944
    ds_write_b32 v8, v29 offset:13296
    s_waitcnt lgkmcnt(0)
    ds_read_b128 v[32:35], v10 offset:0
    ds_read_b128 v[36:39], v10 offset:4352
    ds_read_b128 v[40:43], v10 offset:8704
    ds_read_b128 v[44:47], v10 offset:13056
    s_waitcnt lgkmcnt(0)
    v_mfma_f32_16x16x4_f32 v[12:15], v32, v40, v[12:15]
    v_mfma_f32_16x16x4_f32 v[12:15], v36, v44, v[12:15]
    v_mfma_f32_16x16x4_f32 v[12:15], v33, v41, v[12:15]
    v_mfma_f32_16x16x4_f32 v[12:15], v37, v45, v[12:15]
    v_mfma_f32_16x16x4_f32 v[12:15], v34, v42, v[12:15]
    v_mfma_f32_16x16x4_f32 v[12:15], v38, v46, v[12:15]
    v_mfma_f32_16x16x4_f32 v[12:15], v35, v43, v[12:15]
    v_mfma_f32_16x16x4_f32 v[12:15], v39, v47, v[12:15]
    ds_read_b128 v[32:35], v10 offset:1088
    ds_read_b128 v[36:39], v10 offset:5440
    ds_read_b128 v[40:43], v10 offset:9792
    ds_read_b128 v[44:47], v10 offset:14144
    s_waitcnt lgkmcnt(0)
    v_mfma_f32_16x16x4_f32 v[12:15], v32, v40, v[12:15]
    v_mfma_f32_16x16x4_f32 v[12:15], v36, v44, v[12:15]
    v_mfma_f32_16x16x4_f32 v[12:15], v33, v41, v[12:15]
    v_mfma_f32_16x16x4_f32 v[12:15], v37, v45, v[12:15]
    v_mfma_f32_16x16x4_f32 v[12:15], v34, v42, v[12:15]
    v_mfma_f32_16x16x4_f32 v[12:15], v38, v46, v[12:15]
    v_mfma_f32_16x16x4_f32 v[12:15], v35, v43, v[12:15]
    v_mfma_f32_16x16x4_f32 v[12:15], v39, v47, v[12:15]
    ds_read_b128 v[32:35], v10 offset:2176
    ds_read_b128 v[36:39], v10 offset:6528
    ds_read_b128 v[40:43], v10 offset:10880
    ds_read_b128 v[44:47], v10 offset:15232
    s_waitcnt lgkmcnt(0)
    v_mfma_f32_16x16x4_f32 v[12:15], v32, v40, v[12:15]
    v_mfma_f32_16x16x4_f32 v[12:15], v36, v44, v[12:15]
    v_mfma_f32_16x16x4_f32 v[12:15], v33, v41, v[12:15]
    v_mfma_f32_16x16x4_f32 v[12:15], v37, v45, v[12:15]
    v_mfma_f32_16x16x4_f32 v[12:15], v34, v42, v[12:15]
    v_mfma_f32_16x16x4_f32 v[12:15], v38, v46, v[12:15]
    v_mfma_f32_16x16x4_f32 v[12:15], v35, v43, v[12:15]
    v_mfma_f32_16x16x4_f32 v[12:15], v39, v47, v[12:15]
    ds_read_b128 v[32:35], v10 offset:3264
    ds_read_b128 v[36:39], v10 offset:7616
    ds_read_b128 v[40:43], v10 offset:11968
    ds_read_b128 v[44:47], v10 offset:16320
    s_waitcnt lgkmcnt(0)
    v_mfma_f32_16x16x4_f32 v[12:15], v32, v40, v[12:15]
    v_mfma_f32_16x16x4_f32 v[12:15], v36, v44, v[12:15]
    v_mfma_f32_16x16x4_f32 v[12:15], v33, v41, v[12:15]
    v_mfma_f32_16x16x4_f32 v[12:15], v37, v45, v[12:15]
    v_mfma_f32_16x16x4_f32 v[12:15], v34, v42, v[12:15]
    v_mfma_f32_16x16x4_f32 v[12:15], v38, v46, v[12:15]
    v_mfma_f32_16x16x4_f32 v[12:15], v35, v43, v[12:15]
    v_mfma_f32_16x16x4_f32 v[12:15], v39, v47, v[12:15]
    v_lshlrev_b32 v16, 16, v76
    v_lshlrev_b32 v17, 16, v77
    v_lshlrev_b32 v18, 16, v78
    v_lshlrev_b32 v19, 16, v79
    v_mul_f32 v16, 0x3fb8aa3b, v16
    v_exp_f32 v16, v16
    s_nop 0
    v_cvt_pk_bf16_f32 v16, v16, v16
    v_lshlrev_b32 v16, 16, v16
    v_mul_f32 v20, v16, v4
    v_sub_f32 v20, 0, v20
    v_mul_f32 v21, v17, v4
    v_mul_f32 v18, v18, v4
    v_mul_f32 v19, v19, v4
    v_mul_f32 v30, v20, v5
    v_mul_f32 v30, 0x3fb8aa3b, v30
    v_exp_f32 v30, v30
    v_mul_f32 v31, v21, v5
    v_mul_f32 v31, 0x3e22f983, v31
    v_fract_f32 v31, v31
    v_cos_f32 v22, v31
    v_sin_f32 v23, v31
    s_nop 0
    v_mul_f32 v22, v30, v22
    v_mul_f32 v23, v30, v23
    v_mul_f32 v30, v20, v6
    v_mul_f32 v30, 0x3fb8aa3b, v30
    v_exp_f32 v30, v30
    v_mul_f32 v31, v21, v6
    v_mul_f32 v31, 0x3e22f983, v31
    v_fract_f32 v31, v31
    v_cos_f32 v24, v31
    v_sin_f32 v25, v31
    s_nop 0
    v_mul_f32 v24, v30, v24
    v_mul_f32 v25, v30, v25
    v_mul_f32 v30, v20, v7
    v_mul_f32 v30, 0x3fb8aa3b, v30
    v_exp_f32 v30, v30
    v_mul_f32 v31, v21, v7
    v_mul_f32 v31, 0x3e22f983, v31
    v_fract_f32 v31, v31
    v_cos_f32 v26, v31
    v_sin_f32 v27, v31
    s_nop 0
    v_mul_f32 v26, v30, v26
    v_mul_f32 v27, v30, v27
    v_mul_f32 v30, v26, v18
    v_fma_f32 v30, -v27, v19, v30
    v_mul_f32 v27, v27, v18
    v_fma_f32 v27, v26, v19, v27
    v_mov_b32 v26, v30
    v_mov_b32 v28, 1.0
    v_mov_b32 v29, 0
    ds_write_b32 v8, v26 offset:0
    v_sub_f32 v31, 0, v27
    ds_write_b32 v8, v31 offset:4352
    ds_write_b32 v8, v28 offset:8704
    ds_write_b32 v8, v29 offset:13056
    v_mul_f32 v30, v26, v24
    v_fma_f32 v30, -v27, v25, v30
    v_mul_f32 v27, v27, v24
    v_fma_f32 v27, v26, v25, v27
    v_mov_b32 v26, v30
    v_mul_f32 v30, v28, v22
    v_fma_f32 v30, -v29, v23, v30
    v_mul_f32 v29, v29, v22
    v_fma_f32 v29, v28, v23, v29
    v_mov_b32 v28, v30
    ds_write_b32 v8, v26 offset:16
    v_sub_f32 v31, 0, v27
    ds_write_b32 v8, v31 offset:4368
    ds_write_b32 v8, v28 offset:8720
    ds_write_b32 v8, v29 offset:13072
    v_mul_f32 v30, v26, v24
    v_fma_f32 v30, -v27, v25, v30
    v_mul_f32 v27, v27, v24
    v_fma_f32 v27, v26, v25, v27
    v_mov_b32 v26, v30
    v_mul_f32 v30, v28, v22
    v_fma_f32 v30, -v29, v23, v30
    v_mul_f32 v29, v29, v22
    v_fma_f32 v29, v28, v23, v29
    v_mov_b32 v28, v30
    ds_write_b32 v8, v26 offset:32
    v_sub_f32 v31, 0, v27
    ds_write_b32 v8, v31 offset:4384
    ds_write_b32 v8, v28 offset:8736
    ds_write_b32 v8, v29 offset:13088
    v_mul_f32 v30, v26, v24
    v_fma_f32 v30, -v27, v25, v30
    v_mul_f32 v27, v27, v24
    v_fma_f32 v27, v26, v25, v27
    v_mov_b32 v26, v30
    v_mul_f32 v30, v28, v22
    v_fma_f32 v30, -v29, v23, v30
    v_mul_f32 v29, v29, v22
    v_fma_f32 v29, v28, v23, v29
    v_mov_b32 v28, v30
    ds_write_b32 v8, v26 offset:48
    v_sub_f32 v31, 0, v27
    ds_write_b32 v8, v31 offset:4400
    ds_write_b32 v8, v28 offset:8752
    ds_write_b32 v8, v29 offset:13104
    v_mul_f32 v30, v26, v24
    v_fma_f32 v30, -v27, v25, v30
    v_mul_f32 v27, v27, v24
    v_fma_f32 v27, v26, v25, v27
    v_mov_b32 v26, v30
    v_mul_f32 v30, v28, v22
    v_fma_f32 v30, -v29, v23, v30
    v_mul_f32 v29, v29, v22
    v_fma_f32 v29, v28, v23, v29
    v_mov_b32 v28, v30
    ds_write_b32 v8, v26 offset:64
    v_sub_f32 v31, 0, v27
    ds_write_b32 v8, v31 offset:4416
    ds_write_b32 v8, v28 offset:8768
    ds_write_b32 v8, v29 offset:13120
    v_mul_f32 v30, v26, v24
    v_fma_f32 v30, -v27, v25, v30
    v_mul_f32 v27, v27, v24
    v_fma_f32 v27, v26, v25, v27
    v_mov_b32 v26, v30
    v_mul_f32 v30, v28, v22
    v_fma_f32 v30, -v29, v23, v30
    v_mul_f32 v29, v29, v22
    v_fma_f32 v29, v28, v23, v29
    v_mov_b32 v28, v30
    ds_write_b32 v8, v26 offset:80
    v_sub_f32 v31, 0, v27
    ds_write_b32 v8, v31 offset:4432
    ds_write_b32 v8, v28 offset:8784
    ds_write_b32 v8, v29 offset:13136
    v_mul_f32 v30, v26, v24
    v_fma_f32 v30, -v27, v25, v30
    v_mul_f32 v27, v27, v24
    v_fma_f32 v27, v26, v25, v27
    v_mov_b32 v26, v30
    v_mul_f32 v30, v28, v22
    v_fma_f32 v30, -v29, v23, v30
    v_mul_f32 v29, v29, v22
    v_fma_f32 v29, v28, v23, v29
    v_mov_b32 v28, v30
    ds_write_b32 v8, v26 offset:96
    v_sub_f32 v31, 0, v27
    ds_write_b32 v8, v31 offset:4448
    ds_write_b32 v8, v28 offset:8800
    ds_write_b32 v8, v29 offset:13152
    v_mul_f32 v30, v26, v24
    v_fma_f32 v30, -v27, v25, v30
    v_mul_f32 v27, v27, v24
    v_fma_f32 v27, v26, v25, v27
    v_mov_b32 v26, v30
    v_mul_f32 v30, v28, v22
    v_fma_f32 v30, -v29, v23, v30
    v_mul_f32 v29, v29, v22
    v_fma_f32 v29, v28, v23, v29
    v_mov_b32 v28, v30
    ds_write_b32 v8, v26 offset:112
    v_sub_f32 v31, 0, v27
    ds_write_b32 v8, v31 offset:4464
    ds_write_b32 v8, v28 offset:8816
    ds_write_b32 v8, v29 offset:13168
    v_mul_f32 v30, v26, v24
    v_fma_f32 v30, -v27, v25, v30
    v_mul_f32 v27, v27, v24
    v_fma_f32 v27, v26, v25, v27
    v_mov_b32 v26, v30
    v_mul_f32 v30, v28, v22
    v_fma_f32 v30, -v29, v23, v30
    v_mul_f32 v29, v29, v22
    v_fma_f32 v29, v28, v23, v29
    v_mov_b32 v28, v30
    ds_write_b32 v8, v26 offset:128
    v_sub_f32 v31, 0, v27
    ds_write_b32 v8, v31 offset:4480
    ds_write_b32 v8, v28 offset:8832
    ds_write_b32 v8, v29 offset:13184
    v_mul_f32 v30, v26, v24
    v_fma_f32 v30, -v27, v25, v30
    v_mul_f32 v27, v27, v24
    v_fma_f32 v27, v26, v25, v27
    v_mov_b32 v26, v30
    v_mul_f32 v30, v28, v22
    v_fma_f32 v30, -v29, v23, v30
    v_mul_f32 v29, v29, v22
    v_fma_f32 v29, v28, v23, v29
    v_mov_b32 v28, v30
    ds_write_b32 v8, v26 offset:144
    v_sub_f32 v31, 0, v27
    ds_write_b32 v8, v31 offset:4496
    ds_write_b32 v8, v28 offset:8848
    ds_write_b32 v8, v29 offset:13200
    v_mul_f32 v30, v26, v24
    v_fma_f32 v30, -v27, v25, v30
    v_mul_f32 v27, v27, v24
    v_fma_f32 v27, v26, v25, v27
    v_mov_b32 v26, v30
    v_mul_f32 v30, v28, v22
    v_fma_f32 v30, -v29, v23, v30
    v_mul_f32 v29, v29, v22
    v_fma_f32 v29, v28, v23, v29
    v_mov_b32 v28, v30
    ds_write_b32 v8, v26 offset:160
    v_sub_f32 v31, 0, v27
    ds_write_b32 v8, v31 offset:4512
    ds_write_b32 v8, v28 offset:8864
    ds_write_b32 v8, v29 offset:13216
    v_mul_f32 v30, v26, v24
    v_fma_f32 v30, -v27, v25, v30
    v_mul_f32 v27, v27, v24
    v_fma_f32 v27, v26, v25, v27
    v_mov_b32 v26, v30
    v_mul_f32 v30, v28, v22
    v_fma_f32 v30, -v29, v23, v30
    v_mul_f32 v29, v29, v22
    v_fma_f32 v29, v28, v23, v29
    v_mov_b32 v28, v30
    ds_write_b32 v8, v26 offset:176
    v_sub_f32 v31, 0, v27
    ds_write_b32 v8, v31 offset:4528
    ds_write_b32 v8, v28 offset:8880
    ds_write_b32 v8, v29 offset:13232
    v_mul_f32 v30, v26, v24
    v_fma_f32 v30, -v27, v25, v30
    v_mul_f32 v27, v27, v24
    v_fma_f32 v27, v26, v25, v27
    v_mov_b32 v26, v30
    v_mul_f32 v30, v28, v22
    v_fma_f32 v30, -v29, v23, v30
    v_mul_f32 v29, v29, v22
    v_fma_f32 v29, v28, v23, v29
    v_mov_b32 v28, v30
    ds_write_b32 v8, v26 offset:192
    v_sub_f32 v31, 0, v27
    ds_write_b32 v8, v31 offset:4544
    ds_write_b32 v8, v28 offset:8896
    ds_write_b32 v8, v29 offset:13248
    v_mul_f32 v30, v26, v24
    v_fma_f32 v30, -v27, v25, v30
    v_mul_f32 v27, v27, v24
    v_fma_f32 v27, v26, v25, v27
    v_mov_b32 v26, v30
    v_mul_f32 v30, v28, v22
    v_fma_f32 v30, -v29, v23, v30
    v_mul_f32 v29, v29, v22
    v_fma_f32 v29, v28, v23, v29
    v_mov_b32 v28, v30
    ds_write_b32 v8, v26 offset:208
    v_sub_f32 v31, 0, v27
    ds_write_b32 v8, v31 offset:4560
    ds_write_b32 v8, v28 offset:8912
    ds_write_b32 v8, v29 offset:13264
    v_mul_f32 v30, v26, v24
    v_fma_f32 v30, -v27, v25, v30
    v_mul_f32 v27, v27, v24
    v_fma_f32 v27, v26, v25, v27
    v_mov_b32 v26, v30
    v_mul_f32 v30, v28, v22
    v_fma_f32 v30, -v29, v23, v30
    v_mul_f32 v29, v29, v22
    v_fma_f32 v29, v28, v23, v29
    v_mov_b32 v28, v30
    ds_write_b32 v8, v26 offset:224
    v_sub_f32 v31, 0, v27
    ds_write_b32 v8, v31 offset:4576
    ds_write_b32 v8, v28 offset:8928
    ds_write_b32 v8, v29 offset:13280
    v_mul_f32 v30, v26, v24
    v_fma_f32 v30, -v27, v25, v30
    v_mul_f32 v27, v27, v24
    v_fma_f32 v27, v26, v25, v27
    v_mov_b32 v26, v30
    v_mul_f32 v30, v28, v22
    v_fma_f32 v30, -v29, v23, v30
    v_mul_f32 v29, v29, v22
    v_fma_f32 v29, v28, v23, v29
    v_mov_b32 v28, v30
    ds_write_b32 v8, v26 offset:240
    v_sub_f32 v31, 0, v27
    ds_write_b32 v8, v31 offset:4592
    ds_write_b32 v8, v28 offset:8944
    ds_write_b32 v8, v29 offset:13296
    s_waitcnt lgkmcnt(0)
    ds_read_b128 v[32:35], v10 offset:0
    ds_read_b128 v[36:39], v10 offset:4352
    ds_read_b128 v[40:43], v10 offset:8704
    ds_read_b128 v[44:47], v10 offset:13056
    s_waitcnt lgkmcnt(0)
    v_mfma_f32_16x16x4_f32 v[12:15], v32, v40, v[12:15]
    v_mfma_f32_16x16x4_f32 v[12:15], v36, v44, v[12:15]
    v_mfma_f32_16x16x4_f32 v[12:15], v33, v41, v[12:15]
    v_mfma_f32_16x16x4_f32 v[12:15], v37, v45, v[12:15]
    v_mfma_f32_16x16x4_f32 v[12:15], v34, v42, v[12:15]
    v_mfma_f32_16x16x4_f32 v[12:15], v38, v46, v[12:15]
    v_mfma_f32_16x16x4_f32 v[12:15], v35, v43, v[12:15]
    v_mfma_f32_16x16x4_f32 v[12:15], v39, v47, v[12:15]
    ds_read_b128 v[32:35], v10 offset:1088
    ds_read_b128 v[36:39], v10 offset:5440
    ds_read_b128 v[40:43], v10 offset:9792
    ds_read_b128 v[44:47], v10 offset:14144
    s_waitcnt lgkmcnt(0)
    v_mfma_f32_16x16x4_f32 v[12:15], v32, v40, v[12:15]
    v_mfma_f32_16x16x4_f32 v[12:15], v36, v44, v[12:15]
    v_mfma_f32_16x16x4_f32 v[12:15], v33, v41, v[12:15]
    v_mfma_f32_16x16x4_f32 v[12:15], v37, v45, v[12:15]
    v_mfma_f32_16x16x4_f32 v[12:15], v34, v42, v[12:15]
    v_mfma_f32_16x16x4_f32 v[12:15], v38, v46, v[12:15]
    v_mfma_f32_16x16x4_f32 v[12:15], v35, v43, v[12:15]
    v_mfma_f32_16x16x4_f32 v[12:15], v39, v47, v[12:15]
    ds_read_b128 v[32:35], v10 offset:2176
    ds_read_b128 v[36:39], v10 offset:6528
    ds_read_b128 v[40:43], v10 offset:10880
    ds_read_b128 v[44:47], v10 offset:15232
    s_waitcnt lgkmcnt(0)
    v_mfma_f32_16x16x4_f32 v[12:15], v32, v40, v[12:15]
    v_mfma_f32_16x16x4_f32 v[12:15], v36, v44, v[12:15]
    v_mfma_f32_16x16x4_f32 v[12:15], v33, v41, v[12:15]
    v_mfma_f32_16x16x4_f32 v[12:15], v37, v45, v[12:15]
    v_mfma_f32_16x16x4_f32 v[12:15], v34, v42, v[12:15]
    v_mfma_f32_16x16x4_f32 v[12:15], v38, v46, v[12:15]
    v_mfma_f32_16x16x4_f32 v[12:15], v35, v43, v[12:15]
    v_mfma_f32_16x16x4_f32 v[12:15], v39, v47, v[12:15]
    ds_read_b128 v[32:35], v10 offset:3264
    ds_read_b128 v[36:39], v10 offset:7616
    ds_read_b128 v[40:43], v10 offset:11968
    ds_read_b128 v[44:47], v10 offset:16320
    s_waitcnt lgkmcnt(0)
    v_mfma_f32_16x16x4_f32 v[12:15], v32, v40, v[12:15]
    v_mfma_f32_16x16x4_f32 v[12:15], v36, v44, v[12:15]
    v_mfma_f32_16x16x4_f32 v[12:15], v33, v41, v[12:15]
    v_mfma_f32_16x16x4_f32 v[12:15], v37, v45, v[12:15]
    v_mfma_f32_16x16x4_f32 v[12:15], v34, v42, v[12:15]
    v_mfma_f32_16x16x4_f32 v[12:15], v38, v46, v[12:15]
    v_mfma_f32_16x16x4_f32 v[12:15], v35, v43, v[12:15]
    v_mfma_f32_16x16x4_f32 v[12:15], v39, v47, v[12:15]
    s_nop 11
    v_lshrrev_b32 v16, 4, v1
    v_lshlrev_b32 v16, 6, v16
    v_and_b32 v17, 15, v1
    v_add_u32 v16, v16, v17
    v_lshlrev_b32 v17, 8, v2
    v_add_u32 v16, v16, v17
    v_lshlrev_b32 v16, 2, v16
    s_lshl_b32 s61, s2, 12
    v_add_f32 v12, v12, v12
    v_add_f32 v13, v13, v13
    v_add_f32 v14, v14, v14
    v_add_f32 v15, v15, v15
    buffer_store_dword v12, v16, s[56:59], s61 offen offset:0
    buffer_store_dword v13, v16, s[56:59], s61 offen offset:64
    buffer_store_dword v14, v16, s[56:59], s61 offen offset:128
    buffer_store_dword v15, v16, s[56:59], s61 offen offset:192
    s_endpgm
P_LN:
    s_mov_b32 s36, s4
    s_mov_b32 s37, s5
    s_mov_b32 s38, 0x1c0000
    s_mov_b32 s39, 0x00020000
    s_mov_b32 s40, s32
    s_mov_b32 s41, s33
    s_mov_b32 s42, 0x1c0000
    s_mov_b32 s43, 0x00020000
    s_add_u32 s44, s32, 0x200000
    s_addc_u32 s45, s33, 0
    s_mov_b32 s46, 0x1c0000
    s_mov_b32 s47, 0x00020000
    s_sub_u32 s60, s2, 448
    v_lshrrev_b32 v1, 3, v0
    v_and_b32 v2, 7, v0
    s_lshl_b32 s61, s60, 5
    v_add_u32 v3, s61, v1
    v_mul_u32_u24 v4, 896, v3
    v_lshlrev_b32 v5, 4, v2
    v_add_u32 v4, v4, v5
    buffer_load_dwordx4 v[8:11], v4, s[36:39], 0 offen offset:0
    buffer_load_dwordx4 v[12:15], v4, s[36:39], 0 offen offset:128
    buffer_load_dwordx4 v[16:19], v4, s[36:39], 0 offen offset:256
    buffer_load_dwordx4 v[20:23], v4, s[36:39], 0 offen offset:384
    buffer_load_dwordx4 v[24:27], v4, s[36:39], 0 offen offset:512
    buffer_load_dwordx4 v[28:31], v4, s[36:39], 0 offen offset:640
    buffer_load_dwordx4 v[32:35], v4, s[36:39], 0 offen offset:768
    s_waitcnt vmcnt(0)
    v_lshlrev_b32 v40, 16, v8
    v_and_b32 v41, 0xffff0000, v8
    v_lshlrev_b32 v42, 16, v9
    v_and_b32 v43, 0xffff0000, v9
    v_lshlrev_b32 v44, 16, v10
    v_and_b32 v45, 0xffff0000, v10
    v_lshlrev_b32 v46, 16, v11
    v_and_b32 v47, 0xffff0000, v11
    v_lshlrev_b32 v48, 16, v12
    v_and_b32 v49, 0xffff0000, v12
    v_lshlrev_b32 v50, 16, v13
    v_and_b32 v51, 0xffff0000, v13
    v_lshlrev_b32 v52, 16, v14
    v_and_b32 v53, 0xffff0000, v14
    v_lshlrev_b32 v54, 16, v15
    v_and_b32 v55, 0xffff0000, v15
    v_lshlrev_b32 v56, 16, v16
    v_and_b32 v57, 0xffff0000, v16
    v_lshlrev_b32 v58, 16, v17
    v_and_b32 v59, 0xffff0000, v17
    v_lshlrev_b32 v60, 16, v18
    v_and_b32 v61, 0xffff0000, v18
    v_lshlrev_b32 v62, 16, v19
    v_and_b32 v63, 0xffff0000, v19
    v_lshlrev_b32 v64, 16, v20
    v_and_b32 v65, 0xffff0000, v20
    v_lshlrev_b32 v66, 16, v21
    v_and_b32 v67, 0xffff0000, v21
    v_lshlrev_b32 v68, 16, v22
    v_and_b32 v69, 0xffff0000, v22
    v_lshlrev_b32 v70, 16, v23
    v_and_b32 v71, 0xffff0000, v23
    v_lshlrev_b32 v72, 16, v24
    v_and_b32 v73, 0xffff0000, v24
    v_lshlrev_b32 v74, 16, v25
    v_and_b32 v75, 0xffff0000, v25
    v_lshlrev_b32 v76, 16, v26
    v_and_b32 v77, 0xffff0000, v26
    v_lshlrev_b32 v78, 16, v27
    v_and_b32 v79, 0xffff0000, v27
    v_lshlrev_b32 v80, 16, v28
    v_and_b32 v81, 0xffff0000, v28
    v_lshlrev_b32 v82, 16, v29
    v_and_b32 v83, 0xffff0000, v29
    v_lshlrev_b32 v84, 16, v30
    v_and_b32 v85, 0xffff0000, v30
    v_lshlrev_b32 v86, 16, v31
    v_and_b32 v87, 0xffff0000, v31
    v_lshlrev_b32 v88, 16, v32
    v_and_b32 v89, 0xffff0000, v32
    v_lshlrev_b32 v90, 16, v33
    v_and_b32 v91, 0xffff0000, v33
    v_lshlrev_b32 v92, 16, v34
    v_and_b32 v93, 0xffff0000, v34
    v_lshlrev_b32 v94, 16, v35
    v_and_b32 v95, 0xffff0000, v35
    v_mov_b32 v6, 0
    v_add_f32 v6, v6, v40
    v_add_f32 v6, v6, v41
    v_add_f32 v6, v6, v42
    v_add_f32 v6, v6, v43
    v_add_f32 v6, v6, v44
    v_add_f32 v6, v6, v45
    v_add_f32 v6, v6, v46
    v_add_f32 v6, v6, v47
    v_add_f32 v6, v6, v48
    v_add_f32 v6, v6, v49
    v_add_f32 v6, v6, v50
    v_add_f32 v6, v6, v51
    v_add_f32 v6, v6, v52
    v_add_f32 v6, v6, v53
    v_add_f32 v6, v6, v54
    v_add_f32 v6, v6, v55
    v_add_f32 v6, v6, v56
    v_add_f32 v6, v6, v57
    v_add_f32 v6, v6, v58
    v_add_f32 v6, v6, v59
    v_add_f32 v6, v6, v60
    v_add_f32 v6, v6, v61
    v_add_f32 v6, v6, v62
    v_add_f32 v6, v6, v63
    v_add_f32 v6, v6, v64
    v_add_f32 v6, v6, v65
    v_add_f32 v6, v6, v66
    v_add_f32 v6, v6, v67
    v_add_f32 v6, v6, v68
    v_add_f32 v6, v6, v69
    v_add_f32 v6, v6, v70
    v_add_f32 v6, v6, v71
    v_add_f32 v6, v6, v72
    v_add_f32 v6, v6, v73
    v_add_f32 v6, v6, v74
    v_add_f32 v6, v6, v75
    v_add_f32 v6, v6, v76
    v_add_f32 v6, v6, v77
    v_add_f32 v6, v6, v78
    v_add_f32 v6, v6, v79
    v_add_f32 v6, v6, v80
    v_add_f32 v6, v6, v81
    v_add_f32 v6, v6, v82
    v_add_f32 v6, v6, v83
    v_add_f32 v6, v6, v84
    v_add_f32 v6, v6, v85
    v_add_f32 v6, v6, v86
    v_add_f32 v6, v6, v87
    v_add_f32 v6, v6, v88
    v_add_f32 v6, v6, v89
    v_add_f32 v6, v6, v90
    v_add_f32 v6, v6, v91
    v_add_f32 v6, v6, v92
    v_add_f32 v6, v6, v93
    v_add_f32 v6, v6, v94
    v_add_f32 v6, v6, v95
    ds_swizzle_b32 v7, v6 offset:0x41f
    s_waitcnt lgkmcnt(0)
    v_add_f32 v6, v6, v7
    ds_swizzle_b32 v7, v6 offset:0x81f
    s_waitcnt lgkmcnt(0)
    v_add_f32 v6, v6, v7
    ds_swizzle_b32 v7, v6 offset:0x101f
    s_waitcnt lgkmcnt(0)
    v_add_f32 v6, v6, v7
    v_mul_f32 v6, 0x3b124925, v6
    v_mov_b32 v36, 0
    v_sub_f32 v37, v40, v6
    v_fmac_f32 v36, v37, v37
    v_sub_f32 v37, v41, v6
    v_fmac_f32 v36, v37, v37
    v_sub_f32 v37, v42, v6
    v_fmac_f32 v36, v37, v37
    v_sub_f32 v37, v43, v6
    v_fmac_f32 v36, v37, v37
    v_sub_f32 v37, v44, v6
    v_fmac_f32 v36, v37, v37
    v_sub_f32 v37, v45, v6
    v_fmac_f32 v36, v37, v37
    v_sub_f32 v37, v46, v6
    v_fmac_f32 v36, v37, v37
    v_sub_f32 v37, v47, v6
    v_fmac_f32 v36, v37, v37
    v_sub_f32 v37, v48, v6
    v_fmac_f32 v36, v37, v37
    v_sub_f32 v37, v49, v6
    v_fmac_f32 v36, v37, v37
    v_sub_f32 v37, v50, v6
    v_fmac_f32 v36, v37, v37
    v_sub_f32 v37, v51, v6
    v_fmac_f32 v36, v37, v37
    v_sub_f32 v37, v52, v6
    v_fmac_f32 v36, v37, v37
    v_sub_f32 v37, v53, v6
    v_fmac_f32 v36, v37, v37
    v_sub_f32 v37, v54, v6
    v_fmac_f32 v36, v37, v37
    v_sub_f32 v37, v55, v6
    v_fmac_f32 v36, v37, v37
    v_sub_f32 v37, v56, v6
    v_fmac_f32 v36, v37, v37
    v_sub_f32 v37, v57, v6
    v_fmac_f32 v36, v37, v37
    v_sub_f32 v37, v58, v6
    v_fmac_f32 v36, v37, v37
    v_sub_f32 v37, v59, v6
    v_fmac_f32 v36, v37, v37
    v_sub_f32 v37, v60, v6
    v_fmac_f32 v36, v37, v37
    v_sub_f32 v37, v61, v6
    v_fmac_f32 v36, v37, v37
    v_sub_f32 v37, v62, v6
    v_fmac_f32 v36, v37, v37
    v_sub_f32 v37, v63, v6
    v_fmac_f32 v36, v37, v37
    v_sub_f32 v37, v64, v6
    v_fmac_f32 v36, v37, v37
    v_sub_f32 v37, v65, v6
    v_fmac_f32 v36, v37, v37
    v_sub_f32 v37, v66, v6
    v_fmac_f32 v36, v37, v37
    v_sub_f32 v37, v67, v6
    v_fmac_f32 v36, v37, v37
    v_sub_f32 v37, v68, v6
    v_fmac_f32 v36, v37, v37
    v_sub_f32 v37, v69, v6
    v_fmac_f32 v36, v37, v37
    v_sub_f32 v37, v70, v6
    v_fmac_f32 v36, v37, v37
    v_sub_f32 v37, v71, v6
    v_fmac_f32 v36, v37, v37
    v_sub_f32 v37, v72, v6
    v_fmac_f32 v36, v37, v37
    v_sub_f32 v37, v73, v6
    v_fmac_f32 v36, v37, v37
    v_sub_f32 v37, v74, v6
    v_fmac_f32 v36, v37, v37
    v_sub_f32 v37, v75, v6
    v_fmac_f32 v36, v37, v37
    v_sub_f32 v37, v76, v6
    v_fmac_f32 v36, v37, v37
    v_sub_f32 v37, v77, v6
    v_fmac_f32 v36, v37, v37
    v_sub_f32 v37, v78, v6
    v_fmac_f32 v36, v37, v37
    v_sub_f32 v37, v79, v6
    v_fmac_f32 v36, v37, v37
    v_sub_f32 v37, v80, v6
    v_fmac_f32 v36, v37, v37
    v_sub_f32 v37, v81, v6
    v_fmac_f32 v36, v37, v37
    v_sub_f32 v37, v82, v6
    v_fmac_f32 v36, v37, v37
    v_sub_f32 v37, v83, v6
    v_fmac_f32 v36, v37, v37
    v_sub_f32 v37, v84, v6
    v_fmac_f32 v36, v37, v37
    v_sub_f32 v37, v85, v6
    v_fmac_f32 v36, v37, v37
    v_sub_f32 v37, v86, v6
    v_fmac_f32 v36, v37, v37
    v_sub_f32 v37, v87, v6
    v_fmac_f32 v36, v37, v37
    v_sub_f32 v37, v88, v6
    v_fmac_f32 v36, v37, v37
    v_sub_f32 v37, v89, v6
    v_fmac_f32 v36, v37, v37
    v_sub_f32 v37, v90, v6
    v_fmac_f32 v36, v37, v37
    v_sub_f32 v37, v91, v6
    v_fmac_f32 v36, v37, v37
    v_sub_f32 v37, v92, v6
    v_fmac_f32 v36, v37, v37
    v_sub_f32 v37, v93, v6
    v_fmac_f32 v36, v37, v37
    v_sub_f32 v37, v94, v6
    v_fmac_f32 v36, v37, v37
    v_sub_f32 v37, v95, v6
    v_fmac_f32 v36, v37, v37
    ds_swizzle_b32 v7, v36 offset:0x41f
    s_waitcnt lgkmcnt(0)
    v_add_f32 v36, v36, v7
    ds_swizzle_b32 v7, v36 offset:0x81f
    s_waitcnt lgkmcnt(0)
    v_add_f32 v36, v36, v7
    ds_swizzle_b32 v7, v36 offset:0x101f
    s_waitcnt lgkmcnt(0)
    v_add_f32 v36, v36, v7
    v_mul_f32 v36, 0x3b124925, v36
    v_cvt_pk_bf16_f32 v6, v6, v6
    v_lshlrev_b32 v6, 16, v6
    v_cvt_pk_bf16_f32 v36, v36, v36
    v_lshlrev_b32 v36, 16, v36
    v_add_f32 v36, 0x3727c5ac, v36
    v_cvt_pk_bf16_f32 v36, v36, v36
    v_lshlrev_b32 v36, 16, v36
    v_sqrt_f32 v36, v36
    s_nop 0
    v_cvt_pk_bf16_f32 v36, v36, v36
    v_lshlrev_b32 v36, 16, v36
    v_rcp_f32 v37, v36
    v_lshrrev_b32 v38, 5, v3
    v_mul_u32_u24 v38, 28672, v38
    v_and_b32 v39, 31, v3
    v_lshlrev_b32 v39, 4, v39
    v_add_u32 v38, v38, v39
    v_lshrrev_b32 v39, 1, v2
    v_lshlrev_b32 v39, 10, v39
    v_add_u32 v38, v38, v39
    v_and_b32 v39, 1, v2
    v_lshlrev_b32 v39, 9, v39
    v_add_u32 v38, v38, v39
    v_mul_u32_u24 v39, 912, v1
    v_add_u32 v39, v39, v5
    v_sub_f32 v40, v40, v6
    v_sub_f32 v41, v41, v6
    v_cvt_pk_bf16_f32 v8, v40, v41
    v_lshlrev_b32 v40, 16, v8
    v_and_b32 v41, 0xffff0000, v8
    v_mul_f32 v9, v40, v37
    v_fma_f32 v10, -v9, v36, v40
    v_fma_f32 v40, v10, v37, v9
    v_mul_f32 v9, v41, v37
    v_fma_f32 v10, -v9, v36, v41
    v_fma_f32 v41, v10, v37, v9
    v_cvt_pk_bf16_f32 v12, v40, v41
    v_lshlrev_b32 v40, 16, v12
    v_and_b32 v41, 0xffff0000, v12
    v_cvt_pkrtz_f16_f32 v16, v40, v41
    v_sub_f32 v42, v42, v6
    v_sub_f32 v43, v43, v6
    v_cvt_pk_bf16_f32 v8, v42, v43
    v_lshlrev_b32 v42, 16, v8
    v_and_b32 v43, 0xffff0000, v8
    v_mul_f32 v9, v42, v37
    v_fma_f32 v10, -v9, v36, v42
    v_fma_f32 v42, v10, v37, v9
    v_mul_f32 v9, v43, v37
    v_fma_f32 v10, -v9, v36, v43
    v_fma_f32 v43, v10, v37, v9
    v_cvt_pk_bf16_f32 v13, v42, v43
    v_lshlrev_b32 v42, 16, v13
    v_and_b32 v43, 0xffff0000, v13
    v_cvt_pkrtz_f16_f32 v17, v42, v43
    v_sub_f32 v44, v44, v6
    v_sub_f32 v45, v45, v6
    v_cvt_pk_bf16_f32 v8, v44, v45
    v_lshlrev_b32 v44, 16, v8
    v_and_b32 v45, 0xffff0000, v8
    v_mul_f32 v9, v44, v37
    v_fma_f32 v10, -v9, v36, v44
    v_fma_f32 v44, v10, v37, v9
    v_mul_f32 v9, v45, v37
    v_fma_f32 v10, -v9, v36, v45
    v_fma_f32 v45, v10, v37, v9
    v_cvt_pk_bf16_f32 v14, v44, v45
    v_lshlrev_b32 v44, 16, v14
    v_and_b32 v45, 0xffff0000, v14
    v_cvt_pkrtz_f16_f32 v18, v44, v45
    v_sub_f32 v46, v46, v6
    v_sub_f32 v47, v47, v6
    v_cvt_pk_bf16_f32 v8, v46, v47
    v_lshlrev_b32 v46, 16, v8
    v_and_b32 v47, 0xffff0000, v8
    v_mul_f32 v9, v46, v37
    v_fma_f32 v10, -v9, v36, v46
    v_fma_f32 v46, v10, v37, v9
    v_mul_f32 v9, v47, v37
    v_fma_f32 v10, -v9, v36, v47
    v_fma_f32 v47, v10, v37, v9
    v_cvt_pk_bf16_f32 v15, v46, v47
    v_lshlrev_b32 v46, 16, v15
    v_and_b32 v47, 0xffff0000, v15
    v_cvt_pkrtz_f16_f32 v19, v46, v47
    buffer_store_dwordx4 v[12:15], v38, s[40:43], 0 offen offset:0
    ds_write_b128 v39, v[16:19] offset:0
    s_mov_b32 s62, 4096
    s_nop 1
    v_sub_f32 v48, v48, v6
    v_sub_f32 v49, v49, v6
    v_cvt_pk_bf16_f32 v8, v48, v49
    v_lshlrev_b32 v48, 16, v8
    v_and_b32 v49, 0xffff0000, v8
    v_mul_f32 v9, v48, v37
    v_fma_f32 v10, -v9, v36, v48
    v_fma_f32 v48, v10, v37, v9
    v_mul_f32 v9, v49, v37
    v_fma_f32 v10, -v9, v36, v49
    v_fma_f32 v49, v10, v37, v9
    v_cvt_pk_bf16_f32 v12, v48, v49
    v_lshlrev_b32 v48, 16, v12
    v_and_b32 v49, 0xffff0000, v12
    v_cvt_pkrtz_f16_f32 v16, v48, v49
    v_sub_f32 v50, v50, v6
    v_sub_f32 v51, v51, v6
    v_cvt_pk_bf16_f32 v8, v50, v51
    v_lshlrev_b32 v50, 16, v8
    v_and_b32 v51, 0xffff0000, v8
    v_mul_f32 v9, v50, v37
    v_fma_f32 v10, -v9, v36, v50
    v_fma_f32 v50, v10, v37, v9
    v_mul_f32 v9, v51, v37
    v_fma_f32 v10, -v9, v36, v51
    v_fma_f32 v51, v10, v37, v9
    v_cvt_pk_bf16_f32 v13, v50, v51
    v_lshlrev_b32 v50, 16, v13
    v_and_b32 v51, 0xffff0000, v13
    v_cvt_pkrtz_f16_f32 v17, v50, v51
    v_sub_f32 v52, v52, v6
    v_sub_f32 v53, v53, v6
    v_cvt_pk_bf16_f32 v8, v52, v53
    v_lshlrev_b32 v52, 16, v8
    v_and_b32 v53, 0xffff0000, v8
    v_mul_f32 v9, v52, v37
    v_fma_f32 v10, -v9, v36, v52
    v_fma_f32 v52, v10, v37, v9
    v_mul_f32 v9, v53, v37
    v_fma_f32 v10, -v9, v36, v53
    v_fma_f32 v53, v10, v37, v9
    v_cvt_pk_bf16_f32 v14, v52, v53
    v_lshlrev_b32 v52, 16, v14
    v_and_b32 v53, 0xffff0000, v14
    v_cvt_pkrtz_f16_f32 v18, v52, v53
    v_sub_f32 v54, v54, v6
    v_sub_f32 v55, v55, v6
    v_cvt_pk_bf16_f32 v8, v54, v55
    v_lshlrev_b32 v54, 16, v8
    v_and_b32 v55, 0xffff0000, v8
    v_mul_f32 v9, v54, v37
    v_fma_f32 v10, -v9, v36, v54
    v_fma_f32 v54, v10, v37, v9
    v_mul_f32 v9, v55, v37
    v_fma_f32 v10, -v9, v36, v55
    v_fma_f32 v55, v10, v37, v9
    v_cvt_pk_bf16_f32 v15, v54, v55
    v_lshlrev_b32 v54, 16, v15
    v_and_b32 v55, 0xffff0000, v15
    v_cvt_pkrtz_f16_f32 v19, v54, v55
    buffer_store_dwordx4 v[12:15], v38, s[40:43], s62 offen
    ds_write_b128 v39, v[16:19] offset:128
    s_mov_b32 s62, 8192
    s_nop 1
    v_sub_f32 v56, v56, v6
    v_sub_f32 v57, v57, v6
    v_cvt_pk_bf16_f32 v8, v56, v57
    v_lshlrev_b32 v56, 16, v8
    v_and_b32 v57, 0xffff0000, v8
    v_mul_f32 v9, v56, v37
    v_fma_f32 v10, -v9, v36, v56
    v_fma_f32 v56, v10, v37, v9
    v_mul_f32 v9, v57, v37
    v_fma_f32 v10, -v9, v36, v57
    v_fma_f32 v57, v10, v37, v9
    v_cvt_pk_bf16_f32 v12, v56, v57
    v_lshlrev_b32 v56, 16, v12
    v_and_b32 v57, 0xffff0000, v12
    v_cvt_pkrtz_f16_f32 v16, v56, v57
    v_sub_f32 v58, v58, v6
    v_sub_f32 v59, v59, v6
    v_cvt_pk_bf16_f32 v8, v58, v59
    v_lshlrev_b32 v58, 16, v8
    v_and_b32 v59, 0xffff0000, v8
    v_mul_f32 v9, v58, v37
    v_fma_f32 v10, -v9, v36, v58
    v_fma_f32 v58, v10, v37, v9
    v_mul_f32 v9, v59, v37
    v_fma_f32 v10, -v9, v36, v59
    v_fma_f32 v59, v10, v37, v9
    v_cvt_pk_bf16_f32 v13, v58, v59
    v_lshlrev_b32 v58, 16, v13
    v_and_b32 v59, 0xffff0000, v13
    v_cvt_pkrtz_f16_f32 v17, v58, v59
    v_sub_f32 v60, v60, v6
    v_sub_f32 v61, v61, v6
    v_cvt_pk_bf16_f32 v8, v60, v61
    v_lshlrev_b32 v60, 16, v8
    v_and_b32 v61, 0xffff0000, v8
    v_mul_f32 v9, v60, v37
    v_fma_f32 v10, -v9, v36, v60
    v_fma_f32 v60, v10, v37, v9
    v_mul_f32 v9, v61, v37
    v_fma_f32 v10, -v9, v36, v61
    v_fma_f32 v61, v10, v37, v9
    v_cvt_pk_bf16_f32 v14, v60, v61
    v_lshlrev_b32 v60, 16, v14
    v_and_b32 v61, 0xffff0000, v14
    v_cvt_pkrtz_f16_f32 v18, v60, v61
    v_sub_f32 v62, v62, v6
    v_sub_f32 v63, v63, v6
    v_cvt_pk_bf16_f32 v8, v62, v63
    v_lshlrev_b32 v62, 16, v8
    v_and_b32 v63, 0xffff0000, v8
    v_mul_f32 v9, v62, v37
    v_fma_f32 v10, -v9, v36, v62
    v_fma_f32 v62, v10, v37, v9
    v_mul_f32 v9, v63, v37
    v_fma_f32 v10, -v9, v36, v63
    v_fma_f32 v63, v10, v37, v9
    v_cvt_pk_bf16_f32 v15, v62, v63
    v_lshlrev_b32 v62, 16, v15
    v_and_b32 v63, 0xffff0000, v15
    v_cvt_pkrtz_f16_f32 v19, v62, v63
    buffer_store_dwordx4 v[12:15], v38, s[40:43], s62 offen
    ds_write_b128 v39, v[16:19] offset:256
    s_mov_b32 s62, 12288
    s_nop 1
    v_sub_f32 v64, v64, v6
    v_sub_f32 v65, v65, v6
    v_cvt_pk_bf16_f32 v8, v64, v65
    v_lshlrev_b32 v64, 16, v8
    v_and_b32 v65, 0xffff0000, v8
    v_mul_f32 v9, v64, v37
    v_fma_f32 v10, -v9, v36, v64
    v_fma_f32 v64, v10, v37, v9
    v_mul_f32 v9, v65, v37
    v_fma_f32 v10, -v9, v36, v65
    v_fma_f32 v65, v10, v37, v9
    v_cvt_pk_bf16_f32 v12, v64, v65
    v_lshlrev_b32 v64, 16, v12
    v_and_b32 v65, 0xffff0000, v12
    v_cvt_pkrtz_f16_f32 v16, v64, v65
    v_sub_f32 v66, v66, v6
    v_sub_f32 v67, v67, v6
    v_cvt_pk_bf16_f32 v8, v66, v67
    v_lshlrev_b32 v66, 16, v8
    v_and_b32 v67, 0xffff0000, v8
    v_mul_f32 v9, v66, v37
    v_fma_f32 v10, -v9, v36, v66
    v_fma_f32 v66, v10, v37, v9
    v_mul_f32 v9, v67, v37
    v_fma_f32 v10, -v9, v36, v67
    v_fma_f32 v67, v10, v37, v9
    v_cvt_pk_bf16_f32 v13, v66, v67
    v_lshlrev_b32 v66, 16, v13
    v_and_b32 v67, 0xffff0000, v13
    v_cvt_pkrtz_f16_f32 v17, v66, v67
    v_sub_f32 v68, v68, v6
    v_sub_f32 v69, v69, v6
    v_cvt_pk_bf16_f32 v8, v68, v69
    v_lshlrev_b32 v68, 16, v8
    v_and_b32 v69, 0xffff0000, v8
    v_mul_f32 v9, v68, v37
    v_fma_f32 v10, -v9, v36, v68
    v_fma_f32 v68, v10, v37, v9
    v_mul_f32 v9, v69, v37
    v_fma_f32 v10, -v9, v36, v69
    v_fma_f32 v69, v10, v37, v9
    v_cvt_pk_bf16_f32 v14, v68, v69
    v_lshlrev_b32 v68, 16, v14
    v_and_b32 v69, 0xffff0000, v14
    v_cvt_pkrtz_f16_f32 v18, v68, v69
    v_sub_f32 v70, v70, v6
    v_sub_f32 v71, v71, v6
    v_cvt_pk_bf16_f32 v8, v70, v71
    v_lshlrev_b32 v70, 16, v8
    v_and_b32 v71, 0xffff0000, v8
    v_mul_f32 v9, v70, v37
    v_fma_f32 v10, -v9, v36, v70
    v_fma_f32 v70, v10, v37, v9
    v_mul_f32 v9, v71, v37
    v_fma_f32 v10, -v9, v36, v71
    v_fma_f32 v71, v10, v37, v9
    v_cvt_pk_bf16_f32 v15, v70, v71
    v_lshlrev_b32 v70, 16, v15
    v_and_b32 v71, 0xffff0000, v15
    v_cvt_pkrtz_f16_f32 v19, v70, v71
    buffer_store_dwordx4 v[12:15], v38, s[40:43], s62 offen
    ds_write_b128 v39, v[16:19] offset:384
    s_mov_b32 s62, 16384
    s_nop 1
    v_sub_f32 v72, v72, v6
    v_sub_f32 v73, v73, v6
    v_cvt_pk_bf16_f32 v8, v72, v73
    v_lshlrev_b32 v72, 16, v8
    v_and_b32 v73, 0xffff0000, v8
    v_mul_f32 v9, v72, v37
    v_fma_f32 v10, -v9, v36, v72
    v_fma_f32 v72, v10, v37, v9
    v_mul_f32 v9, v73, v37
    v_fma_f32 v10, -v9, v36, v73
    v_fma_f32 v73, v10, v37, v9
    v_cvt_pk_bf16_f32 v12, v72, v73
    v_lshlrev_b32 v72, 16, v12
    v_and_b32 v73, 0xffff0000, v12
    v_cvt_pkrtz_f16_f32 v16, v72, v73
    v_sub_f32 v74, v74, v6
    v_sub_f32 v75, v75, v6
    v_cvt_pk_bf16_f32 v8, v74, v75
    v_lshlrev_b32 v74, 16, v8
    v_and_b32 v75, 0xffff0000, v8
    v_mul_f32 v9, v74, v37
    v_fma_f32 v10, -v9, v36, v74
    v_fma_f32 v74, v10, v37, v9
    v_mul_f32 v9, v75, v37
    v_fma_f32 v10, -v9, v36, v75
    v_fma_f32 v75, v10, v37, v9
    v_cvt_pk_bf16_f32 v13, v74, v75
    v_lshlrev_b32 v74, 16, v13
    v_and_b32 v75, 0xffff0000, v13
    v_cvt_pkrtz_f16_f32 v17, v74, v75
    v_sub_f32 v76, v76, v6
    v_sub_f32 v77, v77, v6
    v_cvt_pk_bf16_f32 v8, v76, v77
    v_lshlrev_b32 v76, 16, v8
    v_and_b32 v77, 0xffff0000, v8
    v_mul_f32 v9, v76, v37
    v_fma_f32 v10, -v9, v36, v76
    v_fma_f32 v76, v10, v37, v9
    v_mul_f32 v9, v77, v37
    v_fma_f32 v10, -v9, v36, v77
    v_fma_f32 v77, v10, v37, v9
    v_cvt_pk_bf16_f32 v14, v76, v77
    v_lshlrev_b32 v76, 16, v14
    v_and_b32 v77, 0xffff0000, v14
    v_cvt_pkrtz_f16_f32 v18, v76, v77
    v_sub_f32 v78, v78, v6
    v_sub_f32 v79, v79, v6
    v_cvt_pk_bf16_f32 v8, v78, v79
    v_lshlrev_b32 v78, 16, v8
    v_and_b32 v79, 0xffff0000, v8
    v_mul_f32 v9, v78, v37
    v_fma_f32 v10, -v9, v36, v78
    v_fma_f32 v78, v10, v37, v9
    v_mul_f32 v9, v79, v37
    v_fma_f32 v10, -v9, v36, v79
    v_fma_f32 v79, v10, v37, v9
    v_cvt_pk_bf16_f32 v15, v78, v79
    v_lshlrev_b32 v78, 16, v15
    v_and_b32 v79, 0xffff0000, v15
    v_cvt_pkrtz_f16_f32 v19, v78, v79
    buffer_store_dwordx4 v[12:15], v38, s[40:43], s62 offen
    ds_write_b128 v39, v[16:19] offset:512
    s_mov_b32 s62, 20480
    s_nop 1
    v_sub_f32 v80, v80, v6
    v_sub_f32 v81, v81, v6
    v_cvt_pk_bf16_f32 v8, v80, v81
    v_lshlrev_b32 v80, 16, v8
    v_and_b32 v81, 0xffff0000, v8
    v_mul_f32 v9, v80, v37
    v_fma_f32 v10, -v9, v36, v80
    v_fma_f32 v80, v10, v37, v9
    v_mul_f32 v9, v81, v37
    v_fma_f32 v10, -v9, v36, v81
    v_fma_f32 v81, v10, v37, v9
    v_cvt_pk_bf16_f32 v12, v80, v81
    v_lshlrev_b32 v80, 16, v12
    v_and_b32 v81, 0xffff0000, v12
    v_cvt_pkrtz_f16_f32 v16, v80, v81
    v_sub_f32 v82, v82, v6
    v_sub_f32 v83, v83, v6
    v_cvt_pk_bf16_f32 v8, v82, v83
    v_lshlrev_b32 v82, 16, v8
    v_and_b32 v83, 0xffff0000, v8
    v_mul_f32 v9, v82, v37
    v_fma_f32 v10, -v9, v36, v82
    v_fma_f32 v82, v10, v37, v9
    v_mul_f32 v9, v83, v37
    v_fma_f32 v10, -v9, v36, v83
    v_fma_f32 v83, v10, v37, v9
    v_cvt_pk_bf16_f32 v13, v82, v83
    v_lshlrev_b32 v82, 16, v13
    v_and_b32 v83, 0xffff0000, v13
    v_cvt_pkrtz_f16_f32 v17, v82, v83
    v_sub_f32 v84, v84, v6
    v_sub_f32 v85, v85, v6
    v_cvt_pk_bf16_f32 v8, v84, v85
    v_lshlrev_b32 v84, 16, v8
    v_and_b32 v85, 0xffff0000, v8
    v_mul_f32 v9, v84, v37
    v_fma_f32 v10, -v9, v36, v84
    v_fma_f32 v84, v10, v37, v9
    v_mul_f32 v9, v85, v37
    v_fma_f32 v10, -v9, v36, v85
    v_fma_f32 v85, v10, v37, v9
    v_cvt_pk_bf16_f32 v14, v84, v85
    v_lshlrev_b32 v84, 16, v14
    v_and_b32 v85, 0xffff0000, v14
    v_cvt_pkrtz_f16_f32 v18, v84, v85
    v_sub_f32 v86, v86, v6
    v_sub_f32 v87, v87, v6
    v_cvt_pk_bf16_f32 v8, v86, v87
    v_lshlrev_b32 v86, 16, v8
    v_and_b32 v87, 0xffff0000, v8
    v_mul_f32 v9, v86, v37
    v_fma_f32 v10, -v9, v36, v86
    v_fma_f32 v86, v10, v37, v9
    v_mul_f32 v9, v87, v37
    v_fma_f32 v10, -v9, v36, v87
    v_fma_f32 v87, v10, v37, v9
    v_cvt_pk_bf16_f32 v15, v86, v87
    v_lshlrev_b32 v86, 16, v15
    v_and_b32 v87, 0xffff0000, v15
    v_cvt_pkrtz_f16_f32 v19, v86, v87
    buffer_store_dwordx4 v[12:15], v38, s[40:43], s62 offen
    ds_write_b128 v39, v[16:19] offset:640
    s_mov_b32 s62, 24576
    s_nop 1
    v_sub_f32 v88, v88, v6
    v_sub_f32 v89, v89, v6
    v_cvt_pk_bf16_f32 v8, v88, v89
    v_lshlrev_b32 v88, 16, v8
    v_and_b32 v89, 0xffff0000, v8
    v_mul_f32 v9, v88, v37
    v_fma_f32 v10, -v9, v36, v88
    v_fma_f32 v88, v10, v37, v9
    v_mul_f32 v9, v89, v37
    v_fma_f32 v10, -v9, v36, v89
    v_fma_f32 v89, v10, v37, v9
    v_cvt_pk_bf16_f32 v12, v88, v89
    v_lshlrev_b32 v88, 16, v12
    v_and_b32 v89, 0xffff0000, v12
    v_cvt_pkrtz_f16_f32 v16, v88, v89
    v_sub_f32 v90, v90, v6
    v_sub_f32 v91, v91, v6
    v_cvt_pk_bf16_f32 v8, v90, v91
    v_lshlrev_b32 v90, 16, v8
    v_and_b32 v91, 0xffff0000, v8
    v_mul_f32 v9, v90, v37
    v_fma_f32 v10, -v9, v36, v90
    v_fma_f32 v90, v10, v37, v9
    v_mul_f32 v9, v91, v37
    v_fma_f32 v10, -v9, v36, v91
    v_fma_f32 v91, v10, v37, v9
    v_cvt_pk_bf16_f32 v13, v90, v91
    v_lshlrev_b32 v90, 16, v13
    v_and_b32 v91, 0xffff0000, v13
    v_cvt_pkrtz_f16_f32 v17, v90, v91
    v_sub_f32 v92, v92, v6
    v_sub_f32 v93, v93, v6
    v_cvt_pk_bf16_f32 v8, v92, v93
    v_lshlrev_b32 v92, 16, v8
    v_and_b32 v93, 0xffff0000, v8
    v_mul_f32 v9, v92, v37
    v_fma_f32 v10, -v9, v36, v92
    v_fma_f32 v92, v10, v37, v9
    v_mul_f32 v9, v93, v37
    v_fma_f32 v10, -v9, v36, v93
    v_fma_f32 v93, v10, v37, v9
    v_cvt_pk_bf16_f32 v14, v92, v93
    v_lshlrev_b32 v92, 16, v14
    v_and_b32 v93, 0xffff0000, v14
    v_cvt_pkrtz_f16_f32 v18, v92, v93
    v_sub_f32 v94, v94, v6
    v_sub_f32 v95, v95, v6
    v_cvt_pk_bf16_f32 v8, v94, v95
    v_lshlrev_b32 v94, 16, v8
    v_and_b32 v95, 0xffff0000, v8
    v_mul_f32 v9, v94, v37
    v_fma_f32 v10, -v9, v36, v94
    v_fma_f32 v94, v10, v37, v9
    v_mul_f32 v9, v95, v37
    v_fma_f32 v10, -v9, v36, v95
    v_fma_f32 v95, v10, v37, v9
    v_cvt_pk_bf16_f32 v15, v94, v95
    v_lshlrev_b32 v94, 16, v15
    v_and_b32 v95, 0xffff0000, v15
    v_cvt_pkrtz_f16_f32 v19, v94, v95
    buffer_store_dwordx4 v[12:15], v38, s[40:43], s62 offen
    ds_write_b128 v39, v[16:19] offset:768
    s_mov_b32 s62, 28672
    s_nop 1
    s_waitcnt lgkmcnt(0)
    s_barrier
    v_add_u32 v1, 0, v0
    v_lshlrev_b32 v2, 1, v1
    ds_read_u16 v40, v2 offset:0
    ds_read_u16 v41, v2 offset:912
    ds_read_u16 v42, v2 offset:1824
    ds_read_u16 v43, v2 offset:2736
    ds_read_u16 v44, v2 offset:3648
    ds_read_u16 v45, v2 offset:4560
    ds_read_u16 v46, v2 offset:5472
    ds_read_u16 v47, v2 offset:6384
    ds_read_u16 v48, v2 offset:7296
    ds_read_u16 v49, v2 offset:8208
    ds_read_u16 v50, v2 offset:9120
    ds_read_u16 v51, v2 offset:10032
    ds_read_u16 v52, v2 offset:10944
    ds_read_u16 v53, v2 offset:11856
    ds_read_u16 v54, v2 offset:12768
    ds_read_u16 v55, v2 offset:13680
    ds_read_u16 v56, v2 offset:14592
    ds_read_u16 v57, v2 offset:15504
    ds_read_u16 v58, v2 offset:16416
    ds_read_u16 v59, v2 offset:17328
    ds_read_u16 v60, v2 offset:18240
    ds_read_u16 v61, v2 offset:19152
    ds_read_u16 v62, v2 offset:20064
    ds_read_u16 v63, v2 offset:20976
    ds_read_u16 v64, v2 offset:21888
    ds_read_u16 v65, v2 offset:22800
    ds_read_u16 v66, v2 offset:23712
    ds_read_u16 v67, v2 offset:24624
    ds_read_u16 v68, v2 offset:25536
    ds_read_u16 v69, v2 offset:26448
    ds_read_u16 v70, v2 offset:27360
    ds_read_u16 v71, v2 offset:28272
    v_lshlrev_b32 v3, 12, v1
    s_lshl_b32 s63, s60, 6
    s_waitcnt lgkmcnt(0)
    v_lshl_or_b32 v8, v41, 16, v40
    v_lshl_or_b32 v9, v43, 16, v42
    v_lshl_or_b32 v10, v45, 16, v44
    v_lshl_or_b32 v11, v47, 16, v46
    v_lshl_or_b32 v12, v49, 16, v48
    v_lshl_or_b32 v13, v51, 16, v50
    v_lshl_or_b32 v14, v53, 16, v52
    v_lshl_or_b32 v15, v55, 16, v54
    v_lshl_or_b32 v16, v57, 16, v56
    v_lshl_or_b32 v17, v59, 16, v58
    v_lshl_or_b32 v18, v61, 16, v60
    v_lshl_or_b32 v19, v63, 16, v62
    v_lshl_or_b32 v20, v65, 16, v64
    v_lshl_or_b32 v21, v67, 16, v66
    v_lshl_or_b32 v22, v69, 16, v68
    v_lshl_or_b32 v23, v71, 16, v70
    buffer_store_dwordx4 v[8:11], v3, s[44:47], s63 offen offset:0
    buffer_store_dwordx4 v[12:15], v3, s[44:47], s63 offen offset:16
    buffer_store_dwordx4 v[16:19], v3, s[44:47], s63 offen offset:32
    buffer_store_dwordx4 v[20:23], v3, s[44:47], s63 offen offset:48
    v_cmp_gt_u32 vcc, 192, v0
    s_and_saveexec_b64 s[64:65], vcc
    s_cbranch_execz P_LN_DONE
    v_add_u32 v1, 256, v0
    v_lshlrev_b32 v2, 1, v1
    ds_read_u16 v40, v2 offset:0
    ds_read_u16 v41, v2 offset:912
    ds_read_u16 v42, v2 offset:1824
    ds_read_u16 v43, v2 offset:2736
    ds_read_u16 v44, v2 offset:3648
    ds_read_u16 v45, v2 offset:4560
    ds_read_u16 v46, v2 offset:5472
    ds_read_u16 v47, v2 offset:6384
    ds_read_u16 v48, v2 offset:7296
    ds_read_u16 v49, v2 offset:8208
    ds_read_u16 v50, v2 offset:9120
    ds_read_u16 v51, v2 offset:10032
    ds_read_u16 v52, v2 offset:10944
    ds_read_u16 v53, v2 offset:11856
    ds_read_u16 v54, v2 offset:12768
    ds_read_u16 v55, v2 offset:13680
    ds_read_u16 v56, v2 offset:14592
    ds_read_u16 v57, v2 offset:15504
    ds_read_u16 v58, v2 offset:16416
    ds_read_u16 v59, v2 offset:17328
    ds_read_u16 v60, v2 offset:18240
    ds_read_u16 v61, v2 offset:19152
    ds_read_u16 v62, v2 offset:20064
    ds_read_u16 v63, v2 offset:20976
    ds_read_u16 v64, v2 offset:21888
    ds_read_u16 v65, v2 offset:22800
    ds_read_u16 v66, v2 offset:23712
    ds_read_u16 v67, v2 offset:24624
    ds_read_u16 v68, v2 offset:25536
    ds_read_u16 v69, v2 offset:26448
    ds_read_u16 v70, v2 offset:27360
    ds_read_u16 v71, v2 offset:28272
    v_lshlrev_b32 v3, 12, v1
    s_lshl_b32 s63, s60, 6
    s_waitcnt lgkmcnt(0)
    v_lshl_or_b32 v8, v41, 16, v40
    v_lshl_or_b32 v9, v43, 16, v42
    v_lshl_or_b32 v10, v45, 16, v44
    v_lshl_or_b32 v11, v47, 16, v46
    v_lshl_or_b32 v12, v49, 16, v48
    v_lshl_or_b32 v13, v51, 16, v50
    v_lshl_or_b32 v14, v53, 16, v52
    v_lshl_or_b32 v15, v55, 16, v54
    v_lshl_or_b32 v16, v57, 16, v56
    v_lshl_or_b32 v17, v59, 16, v58
    v_lshl_or_b32 v18, v61, 16, v60
    v_lshl_or_b32 v19, v63, 16, v62
    v_lshl_or_b32 v20, v65, 16, v64
    v_lshl_or_b32 v21, v67, 16, v66
    v_lshl_or_b32 v22, v69, 16, v68
    v_lshl_or_b32 v23, v71, 16, v70
    buffer_store_dwordx4 v[8:11], v3, s[44:47], s63 offen offset:0
    buffer_store_dwordx4 v[12:15], v3, s[44:47], s63 offen offset:16
    buffer_store_dwordx4 v[16:19], v3, s[44:47], s63 offen offset:32
    buffer_store_dwordx4 v[20:23], v3, s[44:47], s63 offen offset:48
P_LN_DONE:
    s_endpgm
P_T1:
    s_mov_b32 s36, s20
    s_mov_b32 s37, s21
    s_mov_b32 s38, 0x188000
    s_mov_b32 s39, 0x00020000
    s_add_u32 s40, s32, 0x400000
    s_addc_u32 s41, s33, 0
    s_mov_b32 s42, 0x188000
    s_mov_b32 s43, 0x00020000
    s_sub_u32 s60, s2, 512
    s_mul_hi_u32 s61, s60, 0x24924925
    s_mul_i32 s62, s61, 7
    s_sub_u32 s62, s60, s62
    s_lshl_b32 s62, s62, 8
    v_add_u32 v1, s62, v0
    v_lshlrev_b32 v2, 1, v1
    s_mul_i32 s63, s61, 28672
    s_add_u32 s64, s63, 0
    buffer_load_ushort v16, v2, s[36:39], s64 offen
    s_add_u32 s64, s63, 3584
    buffer_load_ushort v17, v2, s[36:39], s64 offen
    s_add_u32 s64, s63, 7168
    buffer_load_ushort v18, v2, s[36:39], s64 offen
    s_add_u32 s64, s63, 10752
    buffer_load_ushort v19, v2, s[36:39], s64 offen
    s_add_u32 s64, s63, 14336
    buffer_load_ushort v20, v2, s[36:39], s64 offen
    s_add_u32 s64, s63, 17920
    buffer_load_ushort v21, v2, s[36:39], s64 offen
    s_add_u32 s64, s63, 21504
    buffer_load_ushort v22, v2, s[36:39], s64 offen
    s_add_u32 s64, s63, 25088
    buffer_load_ushort v23, v2, s[36:39], s64 offen
    v_lshrrev_b32 v3, 5, v1
    v_mul_u32_u24 v3, 28672, v3
    v_and_b32 v4, 31, v1
    v_lshlrev_b32 v4, 4, v4
    v_add_u32 v3, v3, v4
    s_lshr_b32 s64, s61, 1
    s_lshl_b32 s64, s64, 10
    s_and_b32 s65, s61, 1
    s_lshl_b32 s65, s65, 9
    s_add_u32 s64, s64, s65
    s_waitcnt vmcnt(0)
    v_lshl_or_b32 v8, v17, 16, v16
    v_lshl_or_b32 v9, v19, 16, v18
    v_lshl_or_b32 v10, v21, 16, v20
    v_lshl_or_b32 v11, v23, 16, v22
    buffer_store_dwordx4 v[8:11], v3, s[40:43], s64 offen
    s_endpgm
P_T2:
    s_mov_b32 s36, s24
    s_mov_b32 s37, s25
    s_mov_b32 s38, 0x188000
    s_mov_b32 s39, 0x00020000
    s_add_u32 s40, s32, 0x600000
    s_addc_u32 s41, s33, 0
    s_mov_b32 s42, 0x188000
    s_mov_b32 s43, 0x00020000
    s_sub_u32 s60, s2, 904
    v_lshrrev_b32 v1, 6, v0
    s_nop 0
    v_readfirstlane_b32 s61, v1
    s_lshl_b32 s60, s60, 2
    s_add_u32 s60, s60, s61
    s_mul_hi_u32 s61, s60, 0x24924925
    s_mul_i32 s62, s61, 7
    s_sub_u32 s62, s60, s62
    s_lshl_b32 s62, s62, 6
    v_and_b32 v1, 63, v0
    v_add_u32 v1, s62, v1
    v_lshlrev_b32 v2, 1, v1
    s_mul_i32 s63, s61, 7168
    s_add_u32 s64, s63, 0
    buffer_load_ushort v16, v2, s[36:39], s64 offen
    s_add_u32 s64, s63, 896
    buffer_load_ushort v17, v2, s[36:39], s64 offen
    s_add_u32 s64, s63, 1792
    buffer_load_ushort v18, v2, s[36:39], s64 offen
    s_add_u32 s64, s63, 2688
    buffer_load_ushort v19, v2, s[36:39], s64 offen
    s_add_u32 s64, s63, 3584
    buffer_load_ushort v20, v2, s[36:39], s64 offen
    s_add_u32 s64, s63, 4480
    buffer_load_ushort v21, v2, s[36:39], s64 offen
    s_add_u32 s64, s63, 5376
    buffer_load_ushort v22, v2, s[36:39], s64 offen
    s_add_u32 s64, s63, 6272
    buffer_load_ushort v23, v2, s[36:39], s64 offen
    v_lshrrev_b32 v3, 5, v1
    v_mul_u32_u24 v3, 114688, v3
    v_and_b32 v4, 31, v1
    v_lshlrev_b32 v4, 4, v4
    v_add_u32 v3, v3, v4
    s_lshr_b32 s64, s61, 1
    s_lshl_b32 s64, s64, 10
    s_and_b32 s65, s61, 1
    s_lshl_b32 s65, s65, 9
    s_add_u32 s64, s64, s65
    s_waitcnt vmcnt(0)
    v_lshl_or_b32 v8, v17, 16, v16
    v_lshl_or_b32 v9, v19, 16, v18
    v_lshl_or_b32 v10, v21, 16, v20
    v_lshl_or_b32 v11, v23, 16, v22
    buffer_store_dwordx4 v[8:11], v3, s[40:43], s64 offen
    s_endpgm
.section .rodata,"a"
.p2align 6
.amdhsa_kernel prep_kernel
  .amdhsa_next_free_vgpr 128
  .amdhsa_next_free_sgpr 102
  .amdhsa_accum_offset 128
  .amdhsa_group_segment_fixed_size 0
  .amdhsa_kernarg_size 120
  .amdhsa_user_sgpr_count 2
  .amdhsa_user_sgpr_kernarg_segment_ptr 1
  .amdhsa_system_sgpr_workgroup_id_x 1
.end_amdhsa_kernel
.text
.globl mid_kernel
.p2align 8
.type mid_kernel,@function
mid_kernel:
    s_load_dwordx16 s[4:19], s[0:1], 0
    s_load_dwordx8 s[20:27], s[0:1], 64
    s_load_dwordx4 s[28:31], s[0:1], 96
    s_load_dwordx2 s[32:33], s[0:1], 112
    s_waitcnt lgkmcnt(0)
    s_cmp_lt_u32 s2, 112
    s_cbranch_scc1 M_CONV
    s_cmp_lt_u32 s2, 336
    s_cbranch_scc1 M_G1
    s_endpgm
M_CONV:
    s_add_u32 s36, s32, 0x800000
    s_addc_u32 s37, s33, 0
    s_mov_b32 s38, 0x1c0000
    s_mov_b32 s39, 0x00020000
    s_add_u32 s40, s32, 0x200000
    s_addc_u32 s41, s33, 0
    s_mov_b32 s42, 0x1c0000
    s_mov_b32 s43, 0x00020000
    s_add_u32 s44, s32, 0x1200000
    s_addc_u32 s45, s33, 0
    s_mov_b32 s46, 0x1c0000
    s_mov_b32 s47, 0x00020000
    s_mov_b32 s48, s16
    s_mov_b32 s49, s17
    s_mov_b32 s50, 0x380
    s_mov_b32 s51, 0x00020000
    v_and_b32 v1, 63, v0
    v_lshrrev_b32 v2, 6, v0
    s_nop 0
    v_readfirstlane_b32 s60, v2
    s_lshl_b32 s61, s2, 2
    s_add_u32 s61, s61, s60
    s_mul_i32 s62, s60, 24576
    s_lshl_b32 s63, s61, 12
    s_lshl_b32 s64, s61, 1
    v_mov_b32 v3, 0
    buffer_load_ushort v60, v3, s[48:51], s64 offen
    v_lshlrev_b32 v3, 4, v1
    buffer_load_dwordx4 v[8:11], v3, s[40:43], s63 offen offset:0
    buffer_load_dwordx4 v[12:15], v3, s[40:43], s63 offen offset:1024
    buffer_load_dwordx4 v[16:19], v3, s[40:43], s63 offen offset:2048
    buffer_load_dwordx4 v[20:23], v3, s[40:43], s63 offen offset:3072
    v_mov_b32 v4, 0
    v_mov_b32 v5, 0
    v_mov_b32 v6, 0
    v_mov_b32 v7, 0
    v_add_u32 v30, s62, v3
    ds_write_b128 v30, v[4:7] offset:16896
    ds_write_b128 v30, v[4:7] offset:17920
    v_cmp_gt_u32 vcc, 32, v1
    s_and_saveexec_b64 s[66:67], vcc
    ds_write_b128 v30, v[4:7] offset:18944
    s_mov_b64 exec, s[66:67]
    v_lshrrev_b32 v31, 2, v1
    v_mul_u32_u24 v31, 80, v31
    v_and_b32 v32, 3, v1
    v_lshlrev_b32 v32, 4, v32
    v_add_u32 v31, v31, v32
    v_add_u32 v31, s62, v31
    s_waitcnt vmcnt(0)
    ds_write_b128 v31, v[8:11] offset:19456
    ds_write_b128 v31, v[12:15] offset:20736
    ds_write_b128 v31, v[16:19] offset:22016
    ds_write_b128 v31, v[20:23] offset:23296
    v_lshlrev_b32 v33, 1, v1
    v_add_u32 v33, s62, v33
    v_sub_u32 v8, 2047, v1
    v_max_i32 v9, 1, v8
    v_ffbh_u32 v10, v9
    v_sub_u32 v10, 24, v10
    v_max_i32 v10, 0, v10
    v_lshlrev_b32 v11, v10, 64
    v_lshlrev_b32 v11, 1, v11
    v_cmp_eq_u32 vcc, 0, v10
    s_nop 1
    v_cndmask_b32 v11, v11, 0, vcc
    v_sub_u32 v12, v8, v11
    v_lshrrev_b32 v13, v10, v12
    v_and_b32 v13, 1, v13
    v_lshlrev_b32 v14, v10, 1
    v_lshrrev_b32 v14, 1, v14
    v_add3_u32 v13, v13, v14, v12
    v_add_u32 v13, -1, v13
    v_lshrrev_b32 v13, v10, v13
    v_cndmask_b32 v13, v13, v12, vcc
    v_lshlrev_b32 v10, 8, v10
    v_add_u32 v13, v13, v10
    v_lshlrev_b32 v13, 2, v13
    v_cmp_gt_i32 vcc, 0, v8
    s_nop 1
    v_cndmask_b32 v13, v13, -4, vcc
    buffer_load_dword v64, v13, s[36:39], s63 offen
    v_sub_u32 v8, 1983, v1
    v_max_i32 v9, 1, v8
    v_ffbh_u32 v10, v9
    v_sub_u32 v10, 24, v10
    v_max_i32 v10, 0, v10
    v_lshlrev_b32 v11, v10, 64
    v_lshlrev_b32 v11, 1, v11
    v_cmp_eq_u32 vcc, 0, v10
    s_nop 1
    v_cndmask_b32 v11, v11, 0, vcc
    v_sub_u32 v12, v8, v11
    v_lshrrev_b32 v13, v10, v12
    v_and_b32 v13, 1, v13
    v_lshlrev_b32 v14, v10, 1
    v_lshrrev_b32 v14, 1, v14
    v_add3_u32 v13, v13, v14, v12
    v_add_u32 v13, -1, v13
    v_lshrrev_b32 v13, v10, v13
    v_cndmask_b32 v13, v13, v12, vcc
    v_lshlrev_b32 v10, 8, v10
    v_add_u32 v13, v13, v10
    v_lshlrev_b32 v13, 2, v13
    v_cmp_gt_i32 vcc, 0, v8
    s_nop 1
    v_cndmask_b32 v13, v13, -4, vcc
    buffer_load_dword v65, v13, s[36:39], s63 offen
    v_sub_u32 v8, 1919, v1
    v_max_i32 v9, 1, v8
    v_ffbh_u32 v10, v9
    v_sub_u32 v10, 24, v10
    v_max_i32 v10, 0, v10
    v_lshlrev_b32 v11, v10, 64
    v_lshlrev_b32 v11, 1, v11
    v_cmp_eq_u32 vcc, 0, v10
    s_nop 1
    v_cndmask_b32 v11, v11, 0, vcc
    v_sub_u32 v12, v8, v11
    v_lshrrev_b32 v13, v10, v12
    v_and_b32 v13, 1, v13
    v_lshlrev_b32 v14, v10, 1
    v_lshrrev_b32 v14, 1, v14
    v_add3_u32 v13, v13, v14, v12
    v_add_u32 v13, -1, v13
    v_lshrrev_b32 v13, v10, v13
    v_cndmask_b32 v13, v13, v12, vcc
    v_lshlrev_b32 v10, 8, v10
    v_add_u32 v13, v13, v10
    v_lshlrev_b32 v13, 2, v13
    v_cmp_gt_i32 vcc, 0, v8
    s_nop 1
    v_cndmask_b32 v13, v13, -4, vcc
    buffer_load_dword v66, v13, s[36:39], s63 offen
    v_sub_u32 v8, 1855, v1
    v_max_i32 v9, 1, v8
    v_ffbh_u32 v10, v9
    v_sub_u32 v10, 24, v10
    v_max_i32 v10, 0, v10
    v_lshlrev_b32 v11, v10, 64
    v_lshlrev_b32 v11, 1, v11
    v_cmp_eq_u32 vcc, 0, v10
    s_nop 1
    v_cndmask_b32 v11, v11, 0, vcc
    v_sub_u32 v12, v8, v11
    v_lshrrev_b32 v13, v10, v12
    v_and_b32 v13, 1, v13
    v_lshlrev_b32 v14, v10, 1
    v_lshrrev_b32 v14, 1, v14
    v_add3_u32 v13, v13, v14, v12
    v_add_u32 v13, -1, v13
    v_lshrrev_b32 v13, v10, v13
    v_cndmask_b32 v13, v13, v12, vcc
    v_lshlrev_b32 v10, 8, v10
    v_add_u32 v13, v13, v10
    v_lshlrev_b32 v13, 2, v13
    v_cmp_gt_i32 vcc, 0, v8
    s_nop 1
    v_cndmask_b32 v13, v13, -4, vcc
    buffer_load_dword v67, v13, s[36:39], s63 offen
    v_sub_u32 v8, 1791, v1
    v_max_i32 v9, 1, v8
    v_ffbh_u32 v10, v9
    v_sub_u32 v10, 24, v10
    v_max_i32 v10, 0, v10
    v_lshlrev_b32 v11, v10, 64
    v_lshlrev_b32 v11, 1, v11
    v_cmp_eq_u32 vcc, 0, v10
    s_nop 1
    v_cndmask_b32 v11, v11, 0, vcc
    v_sub_u32 v12, v8, v11
    v_lshrrev_b32 v13, v10, v12
    v_and_b32 v13, 1, v13
    v_lshlrev_b32 v14, v10, 1
    v_lshrrev_b32 v14, 1, v14
    v_add3_u32 v13, v13, v14, v12
    v_add_u32 v13, -1, v13
    v_lshrrev_b32 v13, v10, v13
    v_cndmask_b32 v13, v13, v12, vcc
    v_lshlrev_b32 v10, 8, v10
    v_add_u32 v13, v13, v10
    v_lshlrev_b32 v13, 2, v13
    v_cmp_gt_i32 vcc, 0, v8
    s_nop 1
    v_cndmask_b32 v13, v13, -4, vcc
    buffer_load_dword v68, v13, s[36:39], s63 offen
    v_sub_u32 v8, 1727, v1
    v_max_i32 v9, 1, v8
    v_ffbh_u32 v10, v9
    v_sub_u32 v10, 24, v10
    v_max_i32 v10, 0, v10
    v_lshlrev_b32 v11, v10, 64
    v_lshlrev_b32 v11, 1, v11
    v_cmp_eq_u32 vcc, 0, v10
    s_nop 1
    v_cndmask_b32 v11, v11, 0, vcc
    v_sub_u32 v12, v8, v11
    v_lshrrev_b32 v13, v10, v12
    v_and_b32 v13, 1, v13
    v_lshlrev_b32 v14, v10, 1
    v_lshrrev_b32 v14, 1, v14
    v_add3_u32 v13, v13, v14, v12
    v_add_u32 v13, -1, v13
    v_lshrrev_b32 v13, v10, v13
    v_cndmask_b32 v13, v13, v12, vcc
    v_lshlrev_b32 v10, 8, v10
    v_add_u32 v13, v13, v10
    v_lshlrev_b32 v13, 2, v13
    v_cmp_gt_i32 vcc, 0, v8
    s_nop 1
    v_cndmask_b32 v13, v13, -4, vcc
    buffer_load_dword v69, v13, s[36:39], s63 offen
    v_sub_u32 v8, 1663, v1
    v_max_i32 v9, 1, v8
    v_ffbh_u32 v10, v9
    v_sub_u32 v10, 24, v10
    v_max_i32 v10, 0, v10
    v_lshlrev_b32 v11, v10, 64
    v_lshlrev_b32 v11, 1, v11
    v_cmp_eq_u32 vcc, 0, v10
    s_nop 1
    v_cndmask_b32 v11, v11, 0, vcc
    v_sub_u32 v12, v8, v11
    v_lshrrev_b32 v13, v10, v12
    v_and_b32 v13, 1, v13
    v_lshlrev_b32 v14, v10, 1
    v_lshrrev_b32 v14, 1, v14
    v_add3_u32 v13, v13, v14, v12
    v_add_u32 v13, -1, v13
    v_lshrrev_b32 v13, v10, v13
    v_cndmask_b32 v13, v13, v12, vcc
    v_lshlrev_b32 v10, 8, v10
    v_add_u32 v13, v13, v10
    v_lshlrev_b32 v13, 2, v13
    v_cmp_gt_i32 vcc, 0, v8
    s_nop 1
    v_cndmask_b32 v13, v13, -4, vcc
    buffer_load_dword v70, v13, s[36:39], s63 offen
    v_sub_u32 v8, 1599, v1
    v_max_i32 v9, 1, v8
    v_ffbh_u32 v10, v9
    v_sub_u32 v10, 24, v10
    v_max_i32 v10, 0, v10
    v_lshlrev_b32 v11, v10, 64
    v_lshlrev_b32 v11, 1, v11
    v_cmp_eq_u32 vcc, 0, v10
    s_nop 1
    v_cndmask_b32 v11, v11, 0, vcc
    v_sub_u32 v12, v8, v11
    v_lshrrev_b32 v13, v10, v12
    v_and_b32 v13, 1, v13
    v_lshlrev_b32 v14, v10, 1
    v_lshrrev_b32 v14, 1, v14
    v_add3_u32 v13, v13, v14, v12
    v_add_u32 v13, -1, v13
    v_lshrrev_b32 v13, v10, v13
    v_cndmask_b32 v13, v13, v12, vcc
    v_lshlrev_b32 v10, 8, v10
    v_add_u32 v13, v13, v10
    v_lshlrev_b32 v13, 2, v13
    v_cmp_gt_i32 vcc, 0, v8
    s_nop 1
    v_cndmask_b32 v13, v13, -4, vcc
    buffer_load_dword v71, v13, s[36:39], s63 offen
    v_sub_u32 v8, 1535, v1
    v_max_i32 v9, 1, v8
    v_ffbh_u32 v10, v9
    v_sub_u32 v10, 24, v10
    v_max_i32 v10, 0, v10
    v_lshlrev_b32 v11, v10, 64
    v_lshlrev_b32 v11, 1, v11
    v_cmp_eq_u32 vcc, 0, v10
    s_nop 1
    v_cndmask_b32 v11, v11, 0, vcc
    v_sub_u32 v12, v8, v11
    v_lshrrev_b32 v13, v10, v12
    v_and_b32 v13, 1, v13
    v_lshlrev_b32 v14, v10, 1
    v_lshrrev_b32 v14, 1, v14
    v_add3_u32 v13, v13, v14, v12
    v_add_u32 v13, -1, v13
    v_lshrrev_b32 v13, v10, v13
    v_cndmask_b32 v13, v13, v12, vcc
    v_lshlrev_b32 v10, 8, v10
    v_add_u32 v13, v13, v10
    v_lshlrev_b32 v13, 2, v13
    v_cmp_gt_i32 vcc, 0, v8
    s_nop 1
    v_cndmask_b32 v13, v13, -4, vcc
    buffer_load_dword v72, v13, s[36:39], s63 offen
    v_sub_u32 v8, 1471, v1
    v_max_i32 v9, 1, v8
    v_ffbh_u32 v10, v9
    v_sub_u32 v10, 24, v10
    v_max_i32 v10, 0, v10
    v_lshlrev_b32 v11, v10, 64
    v_lshlrev_b32 v11, 1, v11
    v_cmp_eq_u32 vcc, 0, v10
    s_nop 1
    v_cndmask_b32 v11, v11, 0, vcc
    v_sub_u32 v12, v8, v11
    v_lshrrev_b32 v13, v10, v12
    v_and_b32 v13, 1, v13
    v_lshlrev_b32 v14, v10, 1
    v_lshrrev_b32 v14, 1, v14
    v_add3_u32 v13, v13, v14, v12
    v_add_u32 v13, -1, v13
    v_lshrrev_b32 v13, v10, v13
    v_cndmask_b32 v13, v13, v12, vcc
    v_lshlrev_b32 v10, 8, v10
    v_add_u32 v13, v13, v10
    v_lshlrev_b32 v13, 2, v13
    v_cmp_gt_i32 vcc, 0, v8
    s_nop 1
    v_cndmask_b32 v13, v13, -4, vcc
    buffer_load_dword v73, v13, s[36:39], s63 offen
    v_sub_u32 v8, 1407, v1
    v_max_i32 v9, 1, v8
    v_ffbh_u32 v10, v9
    v_sub_u32 v10, 24, v10
    v_max_i32 v10, 0, v10
    v_lshlrev_b32 v11, v10, 64
    v_lshlrev_b32 v11, 1, v11
    v_cmp_eq_u32 vcc, 0, v10
    s_nop 1
    v_cndmask_b32 v11, v11, 0, vcc
    v_sub_u32 v12, v8, v11
    v_lshrrev_b32 v13, v10, v12
    v_and_b32 v13, 1, v13
    v_lshlrev_b32 v14, v10, 1
    v_lshrrev_b32 v14, 1, v14
    v_add3_u32 v13, v13, v14, v12
    v_add_u32 v13, -1, v13
    v_lshrrev_b32 v13, v10, v13
    v_cndmask_b32 v13, v13, v12, vcc
    v_lshlrev_b32 v10, 8, v10
    v_add_u32 v13, v13, v10
    v_lshlrev_b32 v13, 2, v13
    v_cmp_gt_i32 vcc, 0, v8
    s_nop 1
    v_cndmask_b32 v13, v13, -4, vcc
    buffer_load_dword v74, v13, s[36:39], s63 offen
    v_sub_u32 v8, 1343, v1
    v_max_i32 v9, 1, v8
    v_ffbh_u32 v10, v9
    v_sub_u32 v10, 24, v10
    v_max_i32 v10, 0, v10
    v_lshlrev_b32 v11, v10, 64
    v_lshlrev_b32 v11, 1, v11
    v_cmp_eq_u32 vcc, 0, v10
    s_nop 1
    v_cndmask_b32 v11, v11, 0, vcc
    v_sub_u32 v12, v8, v11
    v_lshrrev_b32 v13, v10, v12
    v_and_b32 v13, 1, v13
    v_lshlrev_b32 v14, v10, 1
    v_lshrrev_b32 v14, 1, v14
    v_add3_u32 v13, v13, v14, v12
    v_add_u32 v13, -1, v13
    v_lshrrev_b32 v13, v10, v13
    v_cndmask_b32 v13, v13, v12, vcc
    v_lshlrev_b32 v10, 8, v10
    v_add_u32 v13, v13, v10
    v_lshlrev_b32 v13, 2, v13
    v_cmp_gt_i32 vcc, 0, v8
    s_nop 1
    v_cndmask_b32 v13, v13, -4, vcc
    buffer_load_dword v75, v13, s[36:39], s63 offen
    v_sub_u32 v8, 1279, v1
    v_max_i32 v9, 1, v8
    v_ffbh_u32 v10, v9
    v_sub_u32 v10, 24, v10
    v_max_i32 v10, 0, v10
    v_lshlrev_b32 v11, v10, 64
    v_lshlrev_b32 v11, 1, v11
    v_cmp_eq_u32 vcc, 0, v10
    s_nop 1
    v_cndmask_b32 v11, v11, 0, vcc
    v_sub_u32 v12, v8, v11
    v_lshrrev_b32 v13, v10, v12
    v_and_b32 v13, 1, v13
    v_lshlrev_b32 v14, v10, 1
    v_lshrrev_b32 v14, 1, v14
    v_add3_u32 v13, v13, v14, v12
    v_add_u32 v13, -1, v13
    v_lshrrev_b32 v13, v10, v13
    v_cndmask_b32 v13, v13, v12, vcc
    v_lshlrev_b32 v10, 8, v10
    v_add_u32 v13, v13, v10
    v_lshlrev_b32 v13, 2, v13
    v_cmp_gt_i32 vcc, 0, v8
    s_nop 1
    v_cndmask_b32 v13, v13, -4, vcc
    buffer_load_dword v76, v13, s[36:39], s63 offen
    v_sub_u32 v8, 1215, v1
    v_max_i32 v9, 1, v8
    v_ffbh_u32 v10, v9
    v_sub_u32 v10, 24, v10
    v_max_i32 v10, 0, v10
    v_lshlrev_b32 v11, v10, 64
    v_lshlrev_b32 v11, 1, v11
    v_cmp_eq_u32 vcc, 0, v10
    s_nop 1
    v_cndmask_b32 v11, v11, 0, vcc
    v_sub_u32 v12, v8, v11
    v_lshrrev_b32 v13, v10, v12
    v_and_b32 v13, 1, v13
    v_lshlrev_b32 v14, v10, 1
    v_lshrrev_b32 v14, 1, v14
    v_add3_u32 v13, v13, v14, v12
    v_add_u32 v13, -1, v13
    v_lshrrev_b32 v13, v10, v13
    v_cndmask_b32 v13, v13, v12, vcc
    v_lshlrev_b32 v10, 8, v10
    v_add_u32 v13, v13, v10
    v_lshlrev_b32 v13, 2, v13
    v_cmp_gt_i32 vcc, 0, v8
    s_nop 1
    v_cndmask_b32 v13, v13, -4, vcc
    buffer_load_dword v77, v13, s[36:39], s63 offen
    v_sub_u32 v8, 1151, v1
    v_max_i32 v9, 1, v8
    v_ffbh_u32 v10, v9
    v_sub_u32 v10, 24, v10
    v_max_i32 v10, 0, v10
    v_lshlrev_b32 v11, v10, 64
    v_lshlrev_b32 v11, 1, v11
    v_cmp_eq_u32 vcc, 0, v10
    s_nop 1
    v_cndmask_b32 v11, v11, 0, vcc
    v_sub_u32 v12, v8, v11
    v_lshrrev_b32 v13, v10, v12
    v_and_b32 v13, 1, v13
    v_lshlrev_b32 v14, v10, 1
    v_lshrrev_b32 v14, 1, v14
    v_add3_u32 v13, v13, v14, v12
    v_add_u32 v13, -1, v13
    v_lshrrev_b32 v13, v10, v13
    v_cndmask_b32 v13, v13, v12, vcc
    v_lshlrev_b32 v10, 8, v10
    v_add_u32 v13, v13, v10
    v_lshlrev_b32 v13, 2, v13
    v_cmp_gt_i32 vcc, 0, v8
    s_nop 1
    v_cndmask_b32 v13, v13, -4, vcc
    buffer_load_dword v78, v13, s[36:39], s63 offen
    v_sub_u32 v8, 1087, v1
    v_max_i32 v9, 1, v8
    v_ffbh_u32 v10, v9
    v_sub_u32 v10, 24, v10
    v_max_i32 v10, 0, v10
    v_lshlrev_b32 v11, v10, 64
    v_lshlrev_b32 v11, 1, v11
    v_cmp_eq_u32 vcc, 0, v10
    s_nop 1
    v_cndmask_b32 v11, v11, 0, vcc
    v_sub_u32 v12, v8, v11
    v_lshrrev_b32 v13, v10, v12
    v_and_b32 v13, 1, v13
    v_lshlrev_b32 v14, v10, 1
    v_lshrrev_b32 v14, 1, v14
    v_add3_u32 v13, v13, v14, v12
    v_add_u32 v13, -1, v13
    v_lshrrev_b32 v13, v10, v13
    v_cndmask_b32 v13, v13, v12, vcc
    v_lshlrev_b32 v10, 8, v10
    v_add_u32 v13, v13, v10
    v_lshlrev_b32 v13, 2, v13
    v_cmp_gt_i32 vcc, 0, v8
    s_nop 1
    v_cndmask_b32 v13, v13, -4, vcc
    buffer_load_dword v79, v13, s[36:39], s63 offen
    v_sub_u32 v8, 1023, v1
    v_max_i32 v9, 1, v8
    v_ffbh_u32 v10, v9
    v_sub_u32 v10, 24, v10
    v_max_i32 v10, 0, v10
    v_lshlrev_b32 v11, v10, 64
    v_lshlrev_b32 v11, 1, v11
    v_cmp_eq_u32 vcc, 0, v10
    s_nop 1
    v_cndmask_b32 v11, v11, 0, vcc
    v_sub_u32 v12, v8, v11
    v_lshrrev_b32 v13, v10, v12
    v_and_b32 v13, 1, v13
    v_lshlrev_b32 v14, v10, 1
    v_lshrrev_b32 v14, 1, v14
    v_add3_u32 v13, v13, v14, v12
    v_add_u32 v13, -1, v13
    v_lshrrev_b32 v13, v10, v13
    v_cndmask_b32 v13, v13, v12, vcc
    v_lshlrev_b32 v10, 8, v10
    v_add_u32 v13, v13, v10
    v_lshlrev_b32 v13, 2, v13
    v_cmp_gt_i32 vcc, 0, v8
    s_nop 1
    v_cndmask_b32 v13, v13, -4, vcc
    buffer_load_dword v80, v13, s[36:39], s63 offen
    v_sub_u32 v8, 959, v1
    v_max_i32 v9, 1, v8
    v_ffbh_u32 v10, v9
    v_sub_u32 v10, 24, v10
    v_max_i32 v10, 0, v10
    v_lshlrev_b32 v11, v10, 64
    v_lshlrev_b32 v11, 1, v11
    v_cmp_eq_u32 vcc, 0, v10
    s_nop 1
    v_cndmask_b32 v11, v11, 0, vcc
    v_sub_u32 v12, v8, v11
    v_lshrrev_b32 v13, v10, v12
    v_and_b32 v13, 1, v13
    v_lshlrev_b32 v14, v10, 1
    v_lshrrev_b32 v14, 1, v14
    v_add3_u32 v13, v13, v14, v12
    v_add_u32 v13, -1, v13
    v_lshrrev_b32 v13, v10, v13
    v_cndmask_b32 v13, v13, v12, vcc
    v_lshlrev_b32 v10, 8, v10
    v_add_u32 v13, v13, v10
    v_lshlrev_b32 v13, 2, v13
    v_cmp_gt_i32 vcc, 0, v8
    s_nop 1
    v_cndmask_b32 v13, v13, -4, vcc
    buffer_load_dword v81, v13, s[36:39], s63 offen
    v_sub_u32 v8, 895, v1
    v_max_i32 v9, 1, v8
    v_ffbh_u32 v10, v9
    v_sub_u32 v10, 24, v10
    v_max_i32 v10, 0, v10
    v_lshlrev_b32 v11, v10, 64
    v_lshlrev_b32 v11, 1, v11
    v_cmp_eq_u32 vcc, 0, v10
    s_nop 1
    v_cndmask_b32 v11, v11, 0, vcc
    v_sub_u32 v12, v8, v11
    v_lshrrev_b32 v13, v10, v12
    v_and_b32 v13, 1, v13
    v_lshlrev_b32 v14, v10, 1
    v_lshrrev_b32 v14, 1, v14
    v_add3_u32 v13, v13, v14, v12
    v_add_u32 v13, -1, v13
    v_lshrrev_b32 v13, v10, v13
    v_cndmask_b32 v13, v13, v12, vcc
    v_lshlrev_b32 v10, 8, v10
    v_add_u32 v13, v13, v10
    v_lshlrev_b32 v13, 2, v13
    v_cmp_gt_i32 vcc, 0, v8
    s_nop 1
    v_cndmask_b32 v13, v13, -4, vcc
    buffer_load_dword v82, v13, s[36:39], s63 offen
    v_sub_u32 v8, 831, v1
    v_max_i32 v9, 1, v8
    v_ffbh_u32 v10, v9
    v_sub_u32 v10, 24, v10
    v_max_i32 v10, 0, v10
    v_lshlrev_b32 v11, v10, 64
    v_lshlrev_b32 v11, 1, v11
    v_cmp_eq_u32 vcc, 0, v10
    s_nop 1
    v_cndmask_b32 v11, v11, 0, vcc
    v_sub_u32 v12, v8, v11
    v_lshrrev_b32 v13, v10, v12
    v_and_b32 v13, 1, v13
    v_lshlrev_b32 v14, v10, 1
    v_lshrrev_b32 v14, 1, v14
    v_add3_u32 v13, v13, v14, v12
    v_add_u32 v13, -1, v13
    v_lshrrev_b32 v13, v10, v13
    v_cndmask_b32 v13, v13, v12, vcc
    v_lshlrev_b32 v10, 8, v10
    v_add_u32 v13, v13, v10
    v_lshlrev_b32 v13, 2, v13
    v_cmp_gt_i32 vcc, 0, v8
    s_nop 1
    v_cndmask_b32 v13, v13, -4, vcc
    buffer_load_dword v83, v13, s[36:39], s63 offen
    v_sub_u32 v8, 767, v1
    v_max_i32 v9, 1, v8
    v_ffbh_u32 v10, v9
    v_sub_u32 v10, 24, v10
    v_max_i32 v10, 0, v10
    v_lshlrev_b32 v11, v10, 64
    v_lshlrev_b32 v11, 1, v11
    v_cmp_eq_u32 vcc, 0, v10
    s_nop 1
    v_cndmask_b32 v11, v11, 0, vcc
    v_sub_u32 v12, v8, v11
    v_lshrrev_b32 v13, v10, v12
    v_and_b32 v13, 1, v13
    v_lshlrev_b32 v14, v10, 1
    v_lshrrev_b32 v14, 1, v14
    v_add3_u32 v13, v13, v14, v12
    v_add_u32 v13, -1, v13
    v_lshrrev_b32 v13, v10, v13
    v_cndmask_b32 v13, v13, v12, vcc
    v_lshlrev_b32 v10, 8, v10
    v_add_u32 v13, v13, v10
    v_lshlrev_b32 v13, 2, v13
    v_cmp_gt_i32 vcc, 0, v8
    s_nop 1
    v_cndmask_b32 v13, v13, -4, vcc
    buffer_load_dword v84, v13, s[36:39], s63 offen
    v_sub_u32 v8, 703, v1
    v_max_i32 v9, 1, v8
    v_ffbh_u32 v10, v9
    v_sub_u32 v10, 24, v10
    v_max_i32 v10, 0, v10
    v_lshlrev_b32 v11, v10, 64
    v_lshlrev_b32 v11, 1, v11
    v_cmp_eq_u32 vcc, 0, v10
    s_nop 1
    v_cndmask_b32 v11, v11, 0, vcc
    v_sub_u32 v12, v8, v11
    v_lshrrev_b32 v13, v10, v12
    v_and_b32 v13, 1, v13
    v_lshlrev_b32 v14, v10, 1
    v_lshrrev_b32 v14, 1, v14
    v_add3_u32 v13, v13, v14, v12
    v_add_u32 v13, -1, v13
    v_lshrrev_b32 v13, v10, v13
    v_cndmask_b32 v13, v13, v12, vcc
    v_lshlrev_b32 v10, 8, v10
    v_add_u32 v13, v13, v10
    v_lshlrev_b32 v13, 2, v13
    v_cmp_gt_i32 vcc, 0, v8
    s_nop 1
    v_cndmask_b32 v13, v13, -4, vcc
    buffer_load_dword v85, v13, s[36:39], s63 offen
    v_sub_u32 v8, 639, v1
    v_max_i32 v9, 1, v8
    v_ffbh_u32 v10, v9
    v_sub_u32 v10, 24, v10
    v_max_i32 v10, 0, v10
    v_lshlrev_b32 v11, v10, 64
    v_lshlrev_b32 v11, 1, v11
    v_cmp_eq_u32 vcc, 0, v10
    s_nop 1
    v_cndmask_b32 v11, v11, 0, vcc
    v_sub_u32 v12, v8, v11
    v_lshrrev_b32 v13, v10, v12
    v_and_b32 v13, 1, v13
    v_lshlrev_b32 v14, v10, 1
    v_lshrrev_b32 v14, 1, v14
    v_add3_u32 v13, v13, v14, v12
    v_add_u32 v13, -1, v13
    v_lshrrev_b32 v13, v10, v13
    v_cndmask_b32 v13, v13, v12, vcc
    v_lshlrev_b32 v10, 8, v10
    v_add_u32 v13, v13, v10
    v_lshlrev_b32 v13, 2, v13
    v_cmp_gt_i32 vcc, 0, v8
    s_nop 1
    v_cndmask_b32 v13, v13, -4, vcc
    buffer_load_dword v86, v13, s[36:39], s63 offen
    v_sub_u32 v8, 575, v1
    v_max_i32 v9, 1, v8
    v_ffbh_u32 v10, v9
    v_sub_u32 v10, 24, v10
    v_max_i32 v10, 0, v10
    v_lshlrev_b32 v11, v10, 64
    v_lshlrev_b32 v11, 1, v11
    v_cmp_eq_u32 vcc, 0, v10
    s_nop 1
    v_cndmask_b32 v11, v11, 0, vcc
    v_sub_u32 v12, v8, v11
    v_lshrrev_b32 v13, v10, v12
    v_and_b32 v13, 1, v13
    v_lshlrev_b32 v14, v10, 1
    v_lshrrev_b32 v14, 1, v14
    v_add3_u32 v13, v13, v14, v12
    v_add_u32 v13, -1, v13
    v_lshrrev_b32 v13, v10, v13
    v_cndmask_b32 v13, v13, v12, vcc
    v_lshlrev_b32 v10, 8, v10
    v_add_u32 v13, v13, v10
    v_lshlrev_b32 v13, 2, v13
    v_cmp_gt_i32 vcc, 0, v8
    s_nop 1
    v_cndmask_b32 v13, v13, -4, vcc
    buffer_load_dword v87, v13, s[36:39], s63 offen
    v_sub_u32 v8, 511, v1
    v_max_i32 v9, 1, v8
    v_ffbh_u32 v10, v9
    v_sub_u32 v10, 24, v10
    v_max_i32 v10, 0, v10
    v_lshlrev_b32 v11, v10, 64
    v_lshlrev_b32 v11, 1, v11
    v_cmp_eq_u32 vcc, 0, v10
    s_nop 1
    v_cndmask_b32 v11, v11, 0, vcc
    v_sub_u32 v12, v8, v11
    v_lshrrev_b32 v13, v10, v12
    v_and_b32 v13, 1, v13
    v_lshlrev_b32 v14, v10, 1
    v_lshrrev_b32 v14, 1, v14
    v_add3_u32 v13, v13, v14, v12
    v_add_u32 v13, -1, v13
    v_lshrrev_b32 v13, v10, v13
    v_cndmask_b32 v13, v13, v12, vcc
    v_lshlrev_b32 v10, 8, v10
    v_add_u32 v13, v13, v10
    v_lshlrev_b32 v13, 2, v13
    v_cmp_gt_i32 vcc, 0, v8
    s_nop 1
    v_cndmask_b32 v13, v13, -4, vcc
    buffer_load_dword v88, v13, s[36:39], s63 offen
    v_sub_u32 v8, 447, v1
    v_max_i32 v9, 1, v8
    v_ffbh_u32 v10, v9
    v_sub_u32 v10, 24, v10
    v_max_i32 v10, 0, v10
    v_lshlrev_b32 v11, v10, 64
    v_lshlrev_b32 v11, 1, v11
    v_cmp_eq_u32 vcc, 0, v10
    s_nop 1
    v_cndmask_b32 v11, v11, 0, vcc
    v_sub_u32 v12, v8, v11
    v_lshrrev_b32 v13, v10, v12
    v_and_b32 v13, 1, v13
    v_lshlrev_b32 v14, v10, 1
    v_lshrrev_b32 v14, 1, v14
    v_add3_u32 v13, v13, v14, v12
    v_add_u32 v13, -1, v13
    v_lshrrev_b32 v13, v10, v13
    v_cndmask_b32 v13, v13, v12, vcc
    v_lshlrev_b32 v10, 8, v10
    v_add_u32 v13, v13, v10
    v_lshlrev_b32 v13, 2, v13
    v_cmp_gt_i32 vcc, 0, v8
    s_nop 1
    v_cndmask_b32 v13, v13, -4, vcc
    buffer_load_dword v89, v13, s[36:39], s63 offen
    v_sub_u32 v8, 383, v1
    v_max_i32 v9, 1, v8
    v_ffbh_u32 v10, v9
    v_sub_u32 v10, 24, v10
    v_max_i32 v10, 0, v10
    v_lshlrev_b32 v11, v10, 64
    v_lshlrev_b32 v11, 1, v11
    v_cmp_eq_u32 vcc, 0, v10
    s_nop 1
    v_cndmask_b32 v11, v11, 0, vcc
    v_sub_u32 v12, v8, v11
    v_lshrrev_b32 v13, v10, v12
    v_and_b32 v13, 1, v13
    v_lshlrev_b32 v14, v10, 1
    v_lshrrev_b32 v14, 1, v14
    v_add3_u32 v13, v13, v14, v12
    v_add_u32 v13, -1, v13
    v_lshrrev_b32 v13, v10, v13
    v_cndmask_b32 v13, v13, v12, vcc
    v_lshlrev_b32 v10, 8, v10
    v_add_u32 v13, v13, v10
    v_lshlrev_b32 v13, 2, v13
    v_cmp_gt_i32 vcc, 0, v8
    s_nop 1
    v_cndmask_b32 v13, v13, -4, vcc
    buffer_load_dword v90, v13, s[36:39], s63 offen
    v_sub_u32 v8, 319, v1
    v_max_i32 v9, 1, v8
    v_ffbh_u32 v10, v9
    v_sub_u32 v10, 24, v10
    v_max_i32 v10, 0, v10
    v_lshlrev_b32 v11, v10, 64
    v_lshlrev_b32 v11, 1, v11
    v_cmp_eq_u32 vcc, 0, v10
    s_nop 1
    v_cndmask_b32 v11, v11, 0, vcc
    v_sub_u32 v12, v8, v11
    v_lshrrev_b32 v13, v10, v12
    v_and_b32 v13, 1, v13
    v_lshlrev_b32 v14, v10, 1
    v_lshrrev_b32 v14, 1, v14
    v_add3_u32 v13, v13, v14, v12
    v_add_u32 v13, -1, v13
    v_lshrrev_b32 v13, v10, v13
    v_cndmask_b32 v13, v13, v12, vcc
    v_lshlrev_b32 v10, 8, v10
    v_add_u32 v13, v13, v10
    v_lshlrev_b32 v13, 2, v13
    v_cmp_gt_i32 vcc, 0, v8
    s_nop 1
    v_cndmask_b32 v13, v13, -4, vcc
    buffer_load_dword v91, v13, s[36:39], s63 offen
    v_sub_u32 v8, 255, v1
    v_max_i32 v9, 1, v8
    v_ffbh_u32 v10, v9
    v_sub_u32 v10, 24, v10
    v_max_i32 v10, 0, v10
    v_lshlrev_b32 v11, v10, 64
    v_lshlrev_b32 v11, 1, v11
    v_cmp_eq_u32 vcc, 0, v10
    s_nop 1
    v_cndmask_b32 v11, v11, 0, vcc
    v_sub_u32 v12, v8, v11
    v_lshrrev_b32 v13, v10, v12
    v_and_b32 v13, 1, v13
    v_lshlrev_b32 v14, v10, 1
    v_lshrrev_b32 v14, 1, v14
    v_add3_u32 v13, v13, v14, v12
    v_add_u32 v13, -1, v13
    v_lshrrev_b32 v13, v10, v13
    v_cndmask_b32 v13, v13, v12, vcc
    v_lshlrev_b32 v10, 8, v10
    v_add_u32 v13, v13, v10
    v_lshlrev_b32 v13, 2, v13
    v_cmp_gt_i32 vcc, 0, v8
    s_nop 1
    v_cndmask_b32 v13, v13, -4, vcc
    buffer_load_dword v92, v13, s[36:39], s63 offen
    v_sub_u32 v8, 191, v1
    v_max_i32 v9, 1, v8
    v_ffbh_u32 v10, v9
    v_sub_u32 v10, 24, v10
    v_max_i32 v10, 0, v10
    v_lshlrev_b32 v11, v10, 64
    v_lshlrev_b32 v11, 1, v11
    v_cmp_eq_u32 vcc, 0, v10
    s_nop 1
    v_cndmask_b32 v11, v11, 0, vcc
    v_sub_u32 v12, v8, v11
    v_lshrrev_b32 v13, v10, v12
    v_and_b32 v13, 1, v13
    v_lshlrev_b32 v14, v10, 1
    v_lshrrev_b32 v14, 1, v14
    v_add3_u32 v13, v13, v14, v12
    v_add_u32 v13, -1, v13
    v_lshrrev_b32 v13, v10, v13
    v_cndmask_b32 v13, v13, v12, vcc
    v_lshlrev_b32 v10, 8, v10
    v_add_u32 v13, v13, v10
    v_lshlrev_b32 v13, 2, v13
    v_cmp_gt_i32 vcc, 0, v8
    s_nop 1
    v_cndmask_b32 v13, v13, -4, vcc
    buffer_load_dword v93, v13, s[36:39], s63 offen
    v_sub_u32 v8, 127, v1
    v_max_i32 v9, 1, v8
    v_ffbh_u32 v10, v9
    v_sub_u32 v10, 24, v10
    v_max_i32 v10, 0, v10
    v_lshlrev_b32 v11, v10, 64
    v_lshlrev_b32 v11, 1, v11
    v_cmp_eq_u32 vcc, 0, v10
    s_nop 1
    v_cndmask_b32 v11, v11, 0, vcc
    v_sub_u32 v12, v8, v11
    v_lshrrev_b32 v13, v10, v12
    v_and_b32 v13, 1, v13
    v_lshlrev_b32 v14, v10, 1
    v_lshrrev_b32 v14, 1, v14
    v_add3_u32 v13, v13, v14, v12
    v_add_u32 v13, -1, v13
    v_lshrrev_b32 v13, v10, v13
    v_cndmask_b32 v13, v13, v12, vcc
    v_lshlrev_b32 v10, 8, v10
    v_add_u32 v13, v13, v10
    v_lshlrev_b32 v13, 2, v13
    v_cmp_gt_i32 vcc, 0, v8
    s_nop 1
    v_cndmask_b32 v13, v13, -4, vcc
    buffer_load_dword v94, v13, s[36:39], s63 offen
    v_sub_u32 v8, 63, v1
    v_max_i32 v9, 1, v8
    v_ffbh_u32 v10, v9
    v_sub_u32 v10, 24, v10
    v_max_i32 v10, 0, v10
    v_lshlrev_b32 v11, v10, 64
    v_lshlrev_b32 v11, 1, v11
    v_cmp_eq_u32 vcc, 0, v10
    s_nop 1
    v_cndmask_b32 v11, v11, 0, vcc
    v_sub_u32 v12, v8, v11
    v_lshrrev_b32 v13, v10, v12
    v_and_b32 v13, 1, v13
    v_lshlrev_b32 v14, v10, 1
    v_lshrrev_b32 v14, 1, v14
    v_add3_u32 v13, v13, v14, v12
    v_add_u32 v13, -1, v13
    v_lshrrev_b32 v13, v10, v13
    v_cndmask_b32 v13, v13, v12, vcc
    v_lshlrev_b32 v10, 8, v10
    v_add_u32 v13, v13, v10
    v_lshlrev_b32 v13, 2, v13
    v_cmp_gt_i32 vcc, 0, v8
    s_nop 1
    v_cndmask_b32 v13, v13, -4, vcc
    buffer_load_dword v95, v13, s[36:39], s63 offen
    v_sub_u32 v8, -1, v1
    v_max_i32 v9, 1, v8
    v_ffbh_u32 v10, v9
    v_sub_u32 v10, 24, v10
    v_max_i32 v10, 0, v10
    v_lshlrev_b32 v11, v10, 64
    v_lshlrev_b32 v11, 1, v11
    v_cmp_eq_u32 vcc, 0, v10
    s_nop 1
    v_cndmask_b32 v11, v11, 0, vcc
    v_sub_u32 v12, v8, v11
    v_lshrrev_b32 v13, v10, v12
    v_and_b32 v13, 1, v13
    v_lshlrev_b32 v14, v10, 1
    v_lshrrev_b32 v14, 1, v14
    v_add3_u32 v13, v13, v14, v12
    v_add_u32 v13, -1, v13
    v_lshrrev_b32 v13, v10, v13
    v_cndmask_b32 v13, v13, v12, vcc
    v_lshlrev_b32 v10, 8, v10
    v_add_u32 v13, v13, v10
    v_lshlrev_b32 v13, 2, v13
    v_cmp_gt_i32 vcc, 0, v8
    s_nop 1
    v_cndmask_b32 v13, v13, -4, vcc
    buffer_load_dword v96, v13, s[36:39], s63 offen
    s_waitcnt vmcnt(0)
    v_cvt_f16_f32 v64, v64
    ds_write_b16 v33, v64 offset:0
    ds_write_b16 v33, v64 offset:4222
    ds_write_b16 v33, v64 offset:8444
    ds_write_b16 v33, v64 offset:12666
    v_cvt_f16_f32 v65, v65
    ds_write_b16 v33, v65 offset:128
    ds_write_b16 v33, v65 offset:4350
    ds_write_b16 v33, v65 offset:8572
    ds_write_b16 v33, v65 offset:12794
    v_cvt_f16_f32 v66, v66
    ds_write_b16 v33, v66 offset:256
    ds_write_b16 v33, v66 offset:4478
    ds_write_b16 v33, v66 offset:8700
    ds_write_b16 v33, v66 offset:12922
    v_cvt_f16_f32 v67, v67
    ds_write_b16 v33, v67 offset:384
    ds_write_b16 v33, v67 offset:4606
    ds_write_b16 v33, v67 offset:8828
    ds_write_b16 v33, v67 offset:13050
    v_cvt_f16_f32 v68, v68
    ds_write_b16 v33, v68 offset:512
    ds_write_b16 v33, v68 offset:4734
    ds_write_b16 v33, v68 offset:8956
    ds_write_b16 v33, v68 offset:13178
    v_cvt_f16_f32 v69, v69
    ds_write_b16 v33, v69 offset:640
    ds_write_b16 v33, v69 offset:4862
    ds_write_b16 v33, v69 offset:9084
    ds_write_b16 v33, v69 offset:13306
    v_cvt_f16_f32 v70, v70
    ds_write_b16 v33, v70 offset:768
    ds_write_b16 v33, v70 offset:4990
    ds_write_b16 v33, v70 offset:9212
    ds_write_b16 v33, v70 offset:13434
    v_cvt_f16_f32 v71, v71
    ds_write_b16 v33, v71 offset:896
    ds_write_b16 v33, v71 offset:5118
    ds_write_b16 v33, v71 offset:9340
    ds_write_b16 v33, v71 offset:13562
    v_cvt_f16_f32 v72, v72
    ds_write_b16 v33, v72 offset:1024
    ds_write_b16 v33, v72 offset:5246
    ds_write_b16 v33, v72 offset:9468
    ds_write_b16 v33, v72 offset:13690
    v_cvt_f16_f32 v73, v73
    ds_write_b16 v33, v73 offset:1152
    ds_write_b16 v33, v73 offset:5374
    ds_write_b16 v33, v73 offset:9596
    ds_write_b16 v33, v73 offset:13818
    v_cvt_f16_f32 v74, v74
    ds_write_b16 v33, v74 offset:1280
    ds_write_b16 v33, v74 offset:5502
    ds_write_b16 v33, v74 offset:9724
    ds_write_b16 v33, v74 offset:13946
    v_cvt_f16_f32 v75, v75
    ds_write_b16 v33, v75 offset:1408
    ds_write_b16 v33, v75 offset:5630
    ds_write_b16 v33, v75 offset:9852
    ds_write_b16 v33, v75 offset:14074
    v_cvt_f16_f32 v76, v76
    ds_write_b16 v33, v76 offset:1536
    ds_write_b16 v33, v76 offset:5758
    ds_write_b16 v33, v76 offset:9980
    ds_write_b16 v33, v76 offset:14202
    v_cvt_f16_f32 v77, v77
    ds_write_b16 v33, v77 offset:1664
    ds_write_b16 v33, v77 offset:5886
    ds_write_b16 v33, v77 offset:10108
    ds_write_b16 v33, v77 offset:14330
    v_cvt_f16_f32 v78, v78
    ds_write_b16 v33, v78 offset:1792
    ds_write_b16 v33, v78 offset:6014
    ds_write_b16 v33, v78 offset:10236
    ds_write_b16 v33, v78 offset:14458
    v_cvt_f16_f32 v79, v79
    ds_write_b16 v33, v79 offset:1920
    ds_write_b16 v33, v79 offset:6142
    ds_write_b16 v33, v79 offset:10364
    ds_write_b16 v33, v79 offset:14586
    v_cvt_f16_f32 v80, v80
    ds_write_b16 v33, v80 offset:2048
    ds_write_b16 v33, v80 offset:6270
    ds_write_b16 v33, v80 offset:10492
    ds_write_b16 v33, v80 offset:14714
    v_cvt_f16_f32 v81, v81
    ds_write_b16 v33, v81 offset:2176
    ds_write_b16 v33, v81 offset:6398
    ds_write_b16 v33, v81 offset:10620
    ds_write_b16 v33, v81 offset:14842
    v_cvt_f16_f32 v82, v82
    ds_write_b16 v33, v82 offset:2304
    ds_write_b16 v33, v82 offset:6526
    ds_write_b16 v33, v82 offset:10748
    ds_write_b16 v33, v82 offset:14970
    v_cvt_f16_f32 v83, v83
    ds_write_b16 v33, v83 offset:2432
    ds_write_b16 v33, v83 offset:6654
    ds_write_b16 v33, v83 offset:10876
    ds_write_b16 v33, v83 offset:15098
    v_cvt_f16_f32 v84, v84
    ds_write_b16 v33, v84 offset:2560
    ds_write_b16 v33, v84 offset:6782
    ds_write_b16 v33, v84 offset:11004
    ds_write_b16 v33, v84 offset:15226
    v_cvt_f16_f32 v85, v85
    ds_write_b16 v33, v85 offset:2688
    ds_write_b16 v33, v85 offset:6910
    ds_write_b16 v33, v85 offset:11132
    ds_write_b16 v33, v85 offset:15354
    v_cvt_f16_f32 v86, v86
    ds_write_b16 v33, v86 offset:2816
    ds_write_b16 v33, v86 offset:7038
    ds_write_b16 v33, v86 offset:11260
    ds_write_b16 v33, v86 offset:15482
    v_cvt_f16_f32 v87, v87
    ds_write_b16 v33, v87 offset:2944
    ds_write_b16 v33, v87 offset:7166
    ds_write_b16 v33, v87 offset:11388
    ds_write_b16 v33, v87 offset:15610
    v_cvt_f16_f32 v88, v88
    ds_write_b16 v33, v88 offset:3072
    ds_write_b16 v33, v88 offset:7294
    ds_write_b16 v33, v88 offset:11516
    ds_write_b16 v33, v88 offset:15738
    v_cvt_f16_f32 v89, v89
    ds_write_b16 v33, v89 offset:3200
    ds_write_b16 v33, v89 offset:7422
    ds_write_b16 v33, v89 offset:11644
    ds_write_b16 v33, v89 offset:15866
    v_cvt_f16_f32 v90, v90
    ds_write_b16 v33, v90 offset:3328
    ds_write_b16 v33, v90 offset:7550
    ds_write_b16 v33, v90 offset:11772
    ds_write_b16 v33, v90 offset:15994
    v_cvt_f16_f32 v91, v91
    ds_write_b16 v33, v91 offset:3456
    ds_write_b16 v33, v91 offset:7678
    ds_write_b16 v33, v91 offset:11900
    ds_write_b16 v33, v91 offset:16122
    v_cvt_f16_f32 v92, v92
    ds_write_b16 v33, v92 offset:3584
    ds_write_b16 v33, v92 offset:7806
    ds_write_b16 v33, v92 offset:12028
    ds_write_b16 v33, v92 offset:16250
    v_cvt_f16_f32 v93, v93
    ds_write_b16 v33, v93 offset:3712
    ds_write_b16 v33, v93 offset:7934
    ds_write_b16 v33, v93 offset:12156
    ds_write_b16 v33, v93 offset:16378
    v_cvt_f16_f32 v94, v94
    ds_write_b16 v33, v94 offset:3840
    ds_write_b16 v33, v94 offset:8062
    ds_write_b16 v33, v94 offset:12284
    ds_write_b16 v33, v94 offset:16506
    v_cvt_f16_f32 v95, v95
    ds_write_b16 v33, v95 offset:3968
    ds_write_b16 v33, v95 offset:8190
    ds_write_b16 v33, v95 offset:12412
    ds_write_b16 v33, v95 offset:16634
    v_cvt_f16_f32 v96, v96
    ds_write_b16 v33, v96 offset:4096
    ds_write_b16 v33, v96 offset:8318
    ds_write_b16 v33, v96 offset:12540
    ds_write_b16 v33, v96 offset:16762
    v_and_b32 v8, 31, v1
    v_lshrrev_b32 v9, 5, v1
    v_lshlrev_b32 v10, 3, v9
    v_sub_u32 v10, v10, v8
    v_add_u32 v10, 31, v10
    v_sub_u32 v11, 3, v8
    v_and_b32 v11, 3, v11
    v_sub_u32 v10, v10, v11
    v_lshlrev_b32 v10, 1, v10
    v_mul_u32_u24 v11, 4224, v11
    v_add_u32 v10, v10, v11
    v_add_u32 v10, s62, v10
    v_mul_u32_u24 v12, 80, v8
    v_lshlrev_b32 v13, 4, v9
    v_add_u32 v12, v12, v13
    v_add_u32 v12, s62, v12
    v_mov_b32 v96, 0
    v_mov_b32 v97, 0
    v_mov_b32 v98, 0
    v_mov_b32 v99, 0
    v_mov_b32 v100, 0
    v_mov_b32 v101, 0
    v_mov_b32 v102, 0
    v_mov_b32 v103, 0
    v_mov_b32 v104, 0
    v_mov_b32 v105, 0
    v_mov_b32 v106, 0
    v_mov_b32 v107, 0
    v_mov_b32 v108, 0
    v_mov_b32 v109, 0
    v_mov_b32 v110, 0
    v_mov_b32 v111, 0
    v_mov_b32 v112, 0
    v_mov_b32 v113, 0
    v_mov_b32 v114, 0
    v_mov_b32 v115, 0
    v_mov_b32 v116, 0
    v_mov_b32 v117, 0
    v_mov_b32 v118, 0
    v_mov_b32 v119, 0
    v_mov_b32 v120, 0
    v_mov_b32 v121, 0
    v_mov_b32 v122, 0
    v_mov_b32 v123, 0
    v_mov_b32 v124, 0
    v_mov_b32 v125, 0
    v_mov_b32 v126, 0
    v_mov_b32 v127, 0
    s_waitcnt lgkmcnt(0)
    ds_read_b64 v[128:129], v10 offset:4032
    ds_read_b64 v[130:131], v10 offset:4040
    ds_read_b128 v[136:139], v12 offset:22016
    ds_read_b128 v[132:135], v12 offset:19456
    ds_read_b64 v[144:145], v10 offset:4064
    ds_read_b64 v[146:147], v10 offset:4072
    ds_read_b128 v[152:155], v12 offset:22048
    ds_read_b128 v[148:151], v12 offset:19488
    ds_read_b64 v[160:161], v10 offset:3968
    ds_read_b64 v[162:163], v10 offset:3976
    ds_read_b128 v[168:171], v12 offset:21936
    ds_read_b128 v[164:167], v12 offset:19376
    ds_read_b64 v[176:177], v10 offset:4000
    ds_read_b64 v[178:179], v10 offset:4008
    ds_read_b128 v[184:187], v12 offset:21968
    ds_read_b128 v[180:183], v12 offset:19408
    s_waitcnt lgkmcnt(12)
    v_mfma_f32_32x32x16_f16 v[112:127], v[128:131], v[136:139], v[112:127]
    v_mfma_f32_32x32x16_f16 v[96:111], v[128:131], v[132:135], v[96:111]
    ds_read_b64 v[128:129], v10 offset:3904
    ds_read_b64 v[130:131], v10 offset:3912
    ds_read_b128 v[136:139], v12 offset:21856
    ds_read_b128 v[132:135], v12 offset:19296
    s_waitcnt lgkmcnt(12)
    v_mfma_f32_32x32x16_f16 v[112:127], v[144:147], v[152:155], v[112:127]
    v_mfma_f32_32x32x16_f16 v[96:111], v[144:147], v[148:151], v[96:111]
    ds_read_b64 v[144:145], v10 offset:3936
    ds_read_b64 v[146:147], v10 offset:3944
    ds_read_b128 v[152:155], v12 offset:21888
    ds_read_b128 v[148:151], v12 offset:19328
    s_waitcnt lgkmcnt(12)
    v_mfma_f32_32x32x16_f16 v[112:127], v[160:163], v[168:171], v[112:127]
    v_mfma_f32_32x32x16_f16 v[96:111], v[160:163], v[164:167], v[96:111]
    ds_read_b64 v[160:161], v10 offset:3840
    ds_read_b64 v[162:163], v10 offset:3848
    ds_read_b128 v[168:171], v12 offset:21776
    ds_read_b128 v[164:167], v12 offset:19216
    s_waitcnt lgkmcnt(12)
    v_mfma_f32_32x32x16_f16 v[112:127], v[176:179], v[184:187], v[112:127]
    v_mfma_f32_32x32x16_f16 v[96:111], v[176:179], v[180:183], v[96:111]
    ds_read_b64 v[176:177], v10 offset:3872
    ds_read_b64 v[178:179], v10 offset:3880
    ds_read_b128 v[184:187], v12 offset:21808
    ds_read_b128 v[180:183], v12 offset:19248
    s_waitcnt lgkmcnt(12)
    v_mfma_f32_32x32x16_f16 v[112:127], v[128:131], v[136:139], v[112:127]
    v_mfma_f32_32x32x16_f16 v[96:111], v[128:131], v[132:135], v[96:111]
    ds_read_b64 v[128:129], v10 offset:3776
    ds_read_b64 v[130:131], v10 offset:3784
    ds_read_b128 v[136:139], v12 offset:21696
    ds_read_b128 v[132:135], v12 offset:19136
    s_waitcnt lgkmcnt(12)
    v_mfma_f32_32x32x16_f16 v[112:127], v[144:147], v[152:155], v[112:127]
    v_mfma_f32_32x32x16_f16 v[96:111], v[144:147], v[148:151], v[96:111]
    ds_read_b64 v[144:145], v10 offset:3808
    ds_read_b64 v[146:147], v10 offset:3816
    ds_read_b128 v[152:155], v12 offset:21728
    ds_read_b128 v[148:151], v12 offset:19168
    s_waitcnt lgkmcnt(12)
    v_mfma_f32_32x32x16_f16 v[112:127], v[160:163], v[168:171], v[112:127]
    v_mfma_f32_32x32x16_f16 v[96:111], v[160:163], v[164:167], v[96:111]
    ds_read_b64 v[160:161], v10 offset:3712
    ds_read_b64 v[162:163], v10 offset:3720
    ds_read_b128 v[168:171], v12 offset:21616
    ds_read_b128 v[164:167], v12 offset:19056
    s_waitcnt lgkmcnt(12)
    v_mfma_f32_32x32x16_f16 v[112:127], v[176:179], v[184:187], v[112:127]
    v_mfma_f32_32x32x16_f16 v[96:111], v[176:179], v[180:183], v[96:111]
    ds_read_b64 v[176:177], v10 offset:3744
    ds_read_b64 v[178:179], v10 offset:3752
    ds_read_b128 v[184:187], v12 offset:21648
    ds_read_b128 v[180:183], v12 offset:19088
    s_waitcnt lgkmcnt(12)
    v_mfma_f32_32x32x16_f16 v[112:127], v[128:131], v[136:139], v[112:127]
    v_mfma_f32_32x32x16_f16 v[96:111], v[128:131], v[132:135], v[96:111]
    ds_read_b64 v[128:129], v10 offset:3648
    ds_read_b64 v[130:131], v10 offset:3656
    ds_read_b128 v[136:139], v12 offset:21536
    ds_read_b128 v[132:135], v12 offset:18976
    s_waitcnt lgkmcnt(12)
    v_mfma_f32_32x32x16_f16 v[112:127], v[144:147], v[152:155], v[112:127]
    v_mfma_f32_32x32x16_f16 v[96:111], v[144:147], v[148:151], v[96:111]
    ds_read_b64 v[144:145], v10 offset:3680
    ds_read_b64 v[146:147], v10 offset:3688
    ds_read_b128 v[152:155], v12 offset:21568
    ds_read_b128 v[148:151], v12 offset:19008
    s_waitcnt lgkmcnt(12)
    v_mfma_f32_32x32x16_f16 v[112:127], v[160:163], v[168:171], v[112:127]
    v_mfma_f32_32x32x16_f16 v[96:111], v[160:163], v[164:167], v[96:111]
    ds_read_b64 v[160:161], v10 offset:3584
    ds_read_b64 v[162:163], v10 offset:3592
    ds_read_b128 v[168:171], v12 offset:21456
    ds_read_b128 v[164:167], v12 offset:18896
    s_waitcnt lgkmcnt(12)
    v_mfma_f32_32x32x16_f16 v[112:127], v[176:179], v[184:187], v[112:127]
    v_mfma_f32_32x32x16_f16 v[96:111], v[176:179], v[180:183], v[96:111]
    ds_read_b64 v[176:177], v10 offset:3616
    ds_read_b64 v[178:179], v10 offset:3624
    ds_read_b128 v[184:187], v12 offset:21488
    ds_read_b128 v[180:183], v12 offset:18928
    s_waitcnt lgkmcnt(12)
    v_mfma_f32_32x32x16_f16 v[112:127], v[128:131], v[136:139], v[112:127]
    v_mfma_f32_32x32x16_f16 v[96:111], v[128:131], v[132:135], v[96:111]
    ds_read_b64 v[128:129], v10 offset:3520
    ds_read_b64 v[130:131], v10 offset:3528
    ds_read_b128 v[136:139], v12 offset:21376
    ds_read_b128 v[132:135], v12 offset:18816
    s_waitcnt lgkmcnt(12)
    v_mfma_f32_32x32x16_f16 v[112:127], v[144:147], v[152:155], v[112:127]
    v_mfma_f32_32x32x16_f16 v[96:111], v[144:147], v[148:151], v[96:111]
    ds_read_b64 v[144:145], v10 offset:3552
    ds_read_b64 v[146:147], v10 offset:3560
    ds_read_b128 v[152:155], v12 offset:21408
    ds_read_b128 v[148:151], v12 offset:18848
    s_waitcnt lgkmcnt(12)
    v_mfma_f32_32x32x16_f16 v[112:127], v[160:163], v[168:171], v[112:127]
    v_mfma_f32_32x32x16_f16 v[96:111], v[160:163], v[164:167], v[96:111]
    ds_read_b64 v[160:161], v10 offset:3456
    ds_read_b64 v[162:163], v10 offset:3464
    ds_read_b128 v[168:171], v12 offset:21296
    ds_read_b128 v[164:167], v12 offset:18736
    s_waitcnt lgkmcnt(12)
    v_mfma_f32_32x32x16_f16 v[112:127], v[176:179], v[184:187], v[112:127]
    v_mfma_f32_32x32x16_f16 v[96:111], v[176:179], v[180:183], v[96:111]
    ds_read_b64 v[176:177], v10 offset:3488
    ds_read_b64 v[178:179], v10 offset:3496
    ds_read_b128 v[184:187], v12 offset:21328
    ds_read_b128 v[180:183], v12 offset:18768
    s_waitcnt lgkmcnt(12)
    v_mfma_f32_32x32x16_f16 v[112:127], v[128:131], v[136:139], v[112:127]
    v_mfma_f32_32x32x16_f16 v[96:111], v[128:131], v[132:135], v[96:111]
    ds_read_b64 v[128:129], v10 offset:3392
    ds_read_b64 v[130:131], v10 offset:3400
    ds_read_b128 v[136:139], v12 offset:21216
    ds_read_b128 v[132:135], v12 offset:18656
    s_waitcnt lgkmcnt(12)
    v_mfma_f32_32x32x16_f16 v[112:127], v[144:147], v[152:155], v[112:127]
    v_mfma_f32_32x32x16_f16 v[96:111], v[144:147], v[148:151], v[96:111]
    ds_read_b64 v[144:145], v10 offset:3424
    ds_read_b64 v[146:147], v10 offset:3432
    ds_read_b128 v[152:155], v12 offset:21248
    ds_read_b128 v[148:151], v12 offset:18688
    s_waitcnt lgkmcnt(12)
    v_mfma_f32_32x32x16_f16 v[112:127], v[160:163], v[168:171], v[112:127]
    v_mfma_f32_32x32x16_f16 v[96:111], v[160:163], v[164:167], v[96:111]
    ds_read_b64 v[160:161], v10 offset:3328
    ds_read_b64 v[162:163], v10 offset:3336
    ds_read_b128 v[168:171], v12 offset:21136
    ds_read_b128 v[164:167], v12 offset:18576
    s_waitcnt lgkmcnt(12)
    v_mfma_f32_32x32x16_f16 v[112:127], v[176:179], v[184:187], v[112:127]
    v_mfma_f32_32x32x16_f16 v[96:111], v[176:179], v[180:183], v[96:111]
    ds_read_b64 v[176:177], v10 offset:3360
    ds_read_b64 v[178:179], v10 offset:3368
    ds_read_b128 v[184:187], v12 offset:21168
    ds_read_b128 v[180:183], v12 offset:18608
    s_waitcnt lgkmcnt(12)
    v_mfma_f32_32x32x16_f16 v[112:127], v[128:131], v[136:139], v[112:127]
    v_mfma_f32_32x32x16_f16 v[96:111], v[128:131], v[132:135], v[96:111]
    ds_read_b64 v[128:129], v10 offset:3264
    ds_read_b64 v[130:131], v10 offset:3272
    ds_read_b128 v[136:139], v12 offset:21056
    ds_read_b128 v[132:135], v12 offset:18496
    s_waitcnt lgkmcnt(12)
    v_mfma_f32_32x32x16_f16 v[112:127], v[144:147], v[152:155], v[112:127]
    v_mfma_f32_32x32x16_f16 v[96:111], v[144:147], v[148:151], v[96:111]
    ds_read_b64 v[144:145], v10 offset:3296
    ds_read_b64 v[146:147], v10 offset:3304
    ds_read_b128 v[152:155], v12 offset:21088
    ds_read_b128 v[148:151], v12 offset:18528
    s_waitcnt lgkmcnt(12)
    v_mfma_f32_32x32x16_f16 v[112:127], v[160:163], v[168:171], v[112:127]
    v_mfma_f32_32x32x16_f16 v[96:111], v[160:163], v[164:167], v[96:111]
    ds_read_b64 v[160:161], v10 offset:3200
    ds_read_b64 v[162:163], v10 offset:3208
    ds_read_b128 v[168:171], v12 offset:20976
    ds_read_b128 v[164:167], v12 offset:18416
    s_waitcnt lgkmcnt(12)
    v_mfma_f32_32x32x16_f16 v[112:127], v[176:179], v[184:187], v[112:127]
    v_mfma_f32_32x32x16_f16 v[96:111], v[176:179], v[180:183], v[96:111]
    ds_read_b64 v[176:177], v10 offset:3232
    ds_read_b64 v[178:179], v10 offset:3240
    ds_read_b128 v[184:187], v12 offset:21008
    ds_read_b128 v[180:183], v12 offset:18448
    s_waitcnt lgkmcnt(12)
    v_mfma_f32_32x32x16_f16 v[112:127], v[128:131], v[136:139], v[112:127]
    v_mfma_f32_32x32x16_f16 v[96:111], v[128:131], v[132:135], v[96:111]
    ds_read_b64 v[128:129], v10 offset:3136
    ds_read_b64 v[130:131], v10 offset:3144
    ds_read_b128 v[136:139], v12 offset:20896
    ds_read_b128 v[132:135], v12 offset:18336
    s_waitcnt lgkmcnt(12)
    v_mfma_f32_32x32x16_f16 v[112:127], v[144:147], v[152:155], v[112:127]
    v_mfma_f32_32x32x16_f16 v[96:111], v[144:147], v[148:151], v[96:111]
    ds_read_b64 v[144:145], v10 offset:3168
    ds_read_b64 v[146:147], v10 offset:3176
    ds_read_b128 v[152:155], v12 offset:20928
    ds_read_b128 v[148:151], v12 offset:18368
    s_waitcnt lgkmcnt(12)
    v_mfma_f32_32x32x16_f16 v[112:127], v[160:163], v[168:171], v[112:127]
    v_mfma_f32_32x32x16_f16 v[96:111], v[160:163], v[164:167], v[96:111]
    ds_read_b64 v[160:161], v10 offset:3072
    ds_read_b64 v[162:163], v10 offset:3080
    ds_read_b128 v[168:171], v12 offset:20816
    ds_read_b128 v[164:167], v12 offset:18256
    s_waitcnt lgkmcnt(12)
    v_mfma_f32_32x32x16_f16 v[112:127], v[176:179], v[184:187], v[112:127]
    v_mfma_f32_32x32x16_f16 v[96:111], v[176:179], v[180:183], v[96:111]
    ds_read_b64 v[176:177], v10 offset:3104
    ds_read_b64 v[178:179], v10 offset:3112
    ds_read_b128 v[184:187], v12 offset:20848
    ds_read_b128 v[180:183], v12 offset:18288
    s_waitcnt lgkmcnt(12)
    v_mfma_f32_32x32x16_f16 v[112:127], v[128:131], v[136:139], v[112:127]
    v_mfma_f32_32x32x16_f16 v[96:111], v[128:131], v[132:135], v[96:111]
    ds_read_b64 v[128:129], v10 offset:3008
    ds_read_b64 v[130:131], v10 offset:3016
    ds_read_b128 v[136:139], v12 offset:20736
    ds_read_b128 v[132:135], v12 offset:18176
    s_waitcnt lgkmcnt(12)
    v_mfma_f32_32x32x16_f16 v[112:127], v[144:147], v[152:155], v[112:127]
    v_mfma_f32_32x32x16_f16 v[96:111], v[144:147], v[148:151], v[96:111]
    ds_read_b64 v[144:145], v10 offset:3040
    ds_read_b64 v[146:147], v10 offset:3048
    ds_read_b128 v[152:155], v12 offset:20768
    ds_read_b128 v[148:151], v12 offset:18208
    s_waitcnt lgkmcnt(12)
    v_mfma_f32_32x32x16_f16 v[112:127], v[160:163], v[168:171], v[112:127]
    v_mfma_f32_32x32x16_f16 v[96:111], v[160:163], v[164:167], v[96:111]
    ds_read_b64 v[160:161], v10 offset:2944
    ds_read_b64 v[162:163], v10 offset:2952
    ds_read_b128 v[168:171], v12 offset:20656
    ds_read_b128 v[164:167], v12 offset:18096
    s_waitcnt lgkmcnt(12)
    v_mfma_f32_32x32x16_f16 v[112:127], v[176:179], v[184:187], v[112:127]
    v_mfma_f32_32x32x16_f16 v[96:111], v[176:179], v[180:183], v[96:111]
    ds_read_b64 v[176:177], v10 offset:2976
    ds_read_b64 v[178:179], v10 offset:2984
    ds_read_b128 v[184:187], v12 offset:20688
    ds_read_b128 v[180:183], v12 offset:18128
    s_waitcnt lgkmcnt(12)
    v_mfma_f32_32x32x16_f16 v[112:127], v[128:131], v[136:139], v[112:127]
    v_mfma_f32_32x32x16_f16 v[96:111], v[128:131], v[132:135], v[96:111]
    ds_read_b64 v[128:129], v10 offset:2880
    ds_read_b64 v[130:131], v10 offset:2888
    ds_read_b128 v[136:139], v12 offset:20576
    ds_read_b128 v[132:135], v12 offset:18016
    s_waitcnt lgkmcnt(12)
    v_mfma_f32_32x32x16_f16 v[112:127], v[144:147], v[152:155], v[112:127]
    v_mfma_f32_32x32x16_f16 v[96:111], v[144:147], v[148:151], v[96:111]
    ds_read_b64 v[144:145], v10 offset:2912
    ds_read_b64 v[146:147], v10 offset:2920
    ds_read_b128 v[152:155], v12 offset:20608
    ds_read_b128 v[148:151], v12 offset:18048
    s_waitcnt lgkmcnt(12)
    v_mfma_f32_32x32x16_f16 v[112:127], v[160:163], v[168:171], v[112:127]
    v_mfma_f32_32x32x16_f16 v[96:111], v[160:163], v[164:167], v[96:111]
    ds_read_b64 v[160:161], v10 offset:2816
    ds_read_b64 v[162:163], v10 offset:2824
    ds_read_b128 v[168:171], v12 offset:20496
    ds_read_b128 v[164:167], v12 offset:17936
    s_waitcnt lgkmcnt(12)
    v_mfma_f32_32x32x16_f16 v[112:127], v[176:179], v[184:187], v[112:127]
    v_mfma_f32_32x32x16_f16 v[96:111], v[176:179], v[180:183], v[96:111]
    ds_read_b64 v[176:177], v10 offset:2848
    ds_read_b64 v[178:179], v10 offset:2856
    ds_read_b128 v[184:187], v12 offset:20528
    ds_read_b128 v[180:183], v12 offset:17968
    s_waitcnt lgkmcnt(12)
    v_mfma_f32_32x32x16_f16 v[112:127], v[128:131], v[136:139], v[112:127]
    v_mfma_f32_32x32x16_f16 v[96:111], v[128:131], v[132:135], v[96:111]
    ds_read_b64 v[128:129], v10 offset:2752
    ds_read_b64 v[130:131], v10 offset:2760
    ds_read_b128 v[136:139], v12 offset:20416
    ds_read_b128 v[132:135], v12 offset:17856
    s_waitcnt lgkmcnt(12)
    v_mfma_f32_32x32x16_f16 v[112:127], v[144:147], v[152:155], v[112:127]
    v_mfma_f32_32x32x16_f16 v[96:111], v[144:147], v[148:151], v[96:111]
    ds_read_b64 v[144:145], v10 offset:2784
    ds_read_b64 v[146:147], v10 offset:2792
    ds_read_b128 v[152:155], v12 offset:20448
    ds_read_b128 v[148:151], v12 offset:17888
    s_waitcnt lgkmcnt(12)
    v_mfma_f32_32x32x16_f16 v[112:127], v[160:163], v[168:171], v[112:127]
    v_mfma_f32_32x32x16_f16 v[96:111], v[160:163], v[164:167], v[96:111]
    ds_read_b64 v[160:161], v10 offset:2688
    ds_read_b64 v[162:163], v10 offset:2696
    ds_read_b128 v[168:171], v12 offset:20336
    ds_read_b128 v[164:167], v12 offset:17776
    s_waitcnt lgkmcnt(12)
    v_mfma_f32_32x32x16_f16 v[112:127], v[176:179], v[184:187], v[112:127]
    v_mfma_f32_32x32x16_f16 v[96:111], v[176:179], v[180:183], v[96:111]
    ds_read_b64 v[176:177], v10 offset:2720
    ds_read_b64 v[178:179], v10 offset:2728
    ds_read_b128 v[184:187], v12 offset:20368
    ds_read_b128 v[180:183], v12 offset:17808
    s_waitcnt lgkmcnt(12)
    v_mfma_f32_32x32x16_f16 v[112:127], v[128:131], v[136:139], v[112:127]
    v_mfma_f32_32x32x16_f16 v[96:111], v[128:131], v[132:135], v[96:111]
    ds_read_b64 v[128:129], v10 offset:2624
    ds_read_b64 v[130:131], v10 offset:2632
    ds_read_b128 v[136:139], v12 offset:20256
    ds_read_b128 v[132:135], v12 offset:17696
    s_waitcnt lgkmcnt(12)
    v_mfma_f32_32x32x16_f16 v[112:127], v[144:147], v[152:155], v[112:127]
    v_mfma_f32_32x32x16_f16 v[96:111], v[144:147], v[148:151], v[96:111]
    ds_read_b64 v[144:145], v10 offset:2656
    ds_read_b64 v[146:147], v10 offset:2664
    ds_read_b128 v[152:155], v12 offset:20288
    ds_read_b128 v[148:151], v12 offset:17728
    s_waitcnt lgkmcnt(12)
    v_mfma_f32_32x32x16_f16 v[112:127], v[160:163], v[168:171], v[112:127]
    v_mfma_f32_32x32x16_f16 v[96:111], v[160:163], v[164:167], v[96:111]
    ds_read_b64 v[160:161], v10 offset:2560
    ds_read_b64 v[162:163], v10 offset:2568
    ds_read_b128 v[168:171], v12 offset:20176
    ds_read_b128 v[164:167], v12 offset:17616
    s_waitcnt lgkmcnt(12)
    v_mfma_f32_32x32x16_f16 v[112:127], v[176:179], v[184:187], v[112:127]
    v_mfma_f32_32x32x16_f16 v[96:111], v[176:179], v[180:183], v[96:111]
    ds_read_b64 v[176:177], v10 offset:2592
    ds_read_b64 v[178:179], v10 offset:2600
    ds_read_b128 v[184:187], v12 offset:20208
    ds_read_b128 v[180:183], v12 offset:17648
    s_waitcnt lgkmcnt(12)
    v_mfma_f32_32x32x16_f16 v[112:127], v[128:131], v[136:139], v[112:127]
    v_mfma_f32_32x32x16_f16 v[96:111], v[128:131], v[132:135], v[96:111]
    ds_read_b64 v[128:129], v10 offset:2496
    ds_read_b64 v[130:131], v10 offset:2504
    ds_read_b128 v[136:139], v12 offset:20096
    ds_read_b128 v[132:135], v12 offset:17536
    s_waitcnt lgkmcnt(12)
    v_mfma_f32_32x32x16_f16 v[112:127], v[144:147], v[152:155], v[112:127]
    v_mfma_f32_32x32x16_f16 v[96:111], v[144:147], v[148:151], v[96:111]
    ds_read_b64 v[144:145], v10 offset:2528
    ds_read_b64 v[146:147], v10 offset:2536
    ds_read_b128 v[152:155], v12 offset:20128
    ds_read_b128 v[148:151], v12 offset:17568
    s_waitcnt lgkmcnt(12)
    v_mfma_f32_32x32x16_f16 v[112:127], v[160:163], v[168:171], v[112:127]
    v_mfma_f32_32x32x16_f16 v[96:111], v[160:163], v[164:167], v[96:111]
    ds_read_b64 v[160:161], v10 offset:2432
    ds_read_b64 v[162:163], v10 offset:2440
    ds_read_b128 v[168:171], v12 offset:20016
    ds_read_b128 v[164:167], v12 offset:17456
    s_waitcnt lgkmcnt(12)
    v_mfma_f32_32x32x16_f16 v[112:127], v[176:179], v[184:187], v[112:127]
    v_mfma_f32_32x32x16_f16 v[96:111], v[176:179], v[180:183], v[96:111]
    ds_read_b64 v[176:177], v10 offset:2464
    ds_read_b64 v[178:179], v10 offset:2472
    ds_read_b128 v[184:187], v12 offset:20048
    ds_read_b128 v[180:183], v12 offset:17488
    s_waitcnt lgkmcnt(12)
    v_mfma_f32_32x32x16_f16 v[112:127], v[128:131], v[136:139], v[112:127]
    v_mfma_f32_32x32x16_f16 v[96:111], v[128:131], v[132:135], v[96:111]
    ds_read_b64 v[128:129], v10 offset:2368
    ds_read_b64 v[130:131], v10 offset:2376
    ds_read_b128 v[136:139], v12 offset:19936
    ds_read_b128 v[132:135], v12 offset:17376
    s_waitcnt lgkmcnt(12)
    v_mfma_f32_32x32x16_f16 v[112:127], v[144:147], v[152:155], v[112:127]
    v_mfma_f32_32x32x16_f16 v[96:111], v[144:147], v[148:151], v[96:111]
    ds_read_b64 v[144:145], v10 offset:2400
    ds_read_b64 v[146:147], v10 offset:2408
    ds_read_b128 v[152:155], v12 offset:19968
    ds_read_b128 v[148:151], v12 offset:17408
    s_waitcnt lgkmcnt(12)
    v_mfma_f32_32x32x16_f16 v[112:127], v[160:163], v[168:171], v[112:127]
    v_mfma_f32_32x32x16_f16 v[96:111], v[160:163], v[164:167], v[96:111]
    ds_read_b64 v[160:161], v10 offset:2304
    ds_read_b64 v[162:163], v10 offset:2312
    ds_read_b128 v[168:171], v12 offset:19856
    ds_read_b128 v[164:167], v12 offset:17296
    s_waitcnt lgkmcnt(12)
    v_mfma_f32_32x32x16_f16 v[112:127], v[176:179], v[184:187], v[112:127]
    v_mfma_f32_32x32x16_f16 v[96:111], v[176:179], v[180:183], v[96:111]
    ds_read_b64 v[176:177], v10 offset:2336
    ds_read_b64 v[178:179], v10 offset:2344
    ds_read_b128 v[184:187], v12 offset:19888
    ds_read_b128 v[180:183], v12 offset:17328
    s_waitcnt lgkmcnt(12)
    v_mfma_f32_32x32x16_f16 v[112:127], v[128:131], v[136:139], v[112:127]
    v_mfma_f32_32x32x16_f16 v[96:111], v[128:131], v[132:135], v[96:111]
    ds_read_b64 v[128:129], v10 offset:2240
    ds_read_b64 v[130:131], v10 offset:2248
    ds_read_b128 v[136:139], v12 offset:19776
    ds_read_b128 v[132:135], v12 offset:17216
    s_waitcnt lgkmcnt(12)
    v_mfma_f32_32x32x16_f16 v[112:127], v[144:147], v[152:155], v[112:127]
    v_mfma_f32_32x32x16_f16 v[96:111], v[144:147], v[148:151], v[96:111]
    ds_read_b64 v[144:145], v10 offset:2272
    ds_read_b64 v[146:147], v10 offset:2280
    ds_read_b128 v[152:155], v12 offset:19808
    ds_read_b128 v[148:151], v12 offset:17248
    s_waitcnt lgkmcnt(12)
    v_mfma_f32_32x32x16_f16 v[112:127], v[160:163], v[168:171], v[112:127]
    v_mfma_f32_32x32x16_f16 v[96:111], v[160:163], v[164:167], v[96:111]
    ds_read_b64 v[160:161], v10 offset:2176
    ds_read_b64 v[162:163], v10 offset:2184
    ds_read_b128 v[168:171], v12 offset:19696
    ds_read_b128 v[164:167], v12 offset:17136
    s_waitcnt lgkmcnt(12)
    v_mfma_f32_32x32x16_f16 v[112:127], v[176:179], v[184:187], v[112:127]
    v_mfma_f32_32x32x16_f16 v[96:111], v[176:179], v[180:183], v[96:111]
    ds_read_b64 v[176:177], v10 offset:2208
    ds_read_b64 v[178:179], v10 offset:2216
    ds_read_b128 v[184:187], v12 offset:19728
    ds_read_b128 v[180:183], v12 offset:17168
    s_waitcnt lgkmcnt(12)
    v_mfma_f32_32x32x16_f16 v[112:127], v[128:131], v[136:139], v[112:127]
    v_mfma_f32_32x32x16_f16 v[96:111], v[128:131], v[132:135], v[96:111]
    ds_read_b64 v[128:129], v10 offset:2112
    ds_read_b64 v[130:131], v10 offset:2120
    ds_read_b128 v[136:139], v12 offset:19616
    ds_read_b128 v[132:135], v12 offset:17056
    s_waitcnt lgkmcnt(12)
    v_mfma_f32_32x32x16_f16 v[112:127], v[144:147], v[152:155], v[112:127]
    v_mfma_f32_32x32x16_f16 v[96:111], v[144:147], v[148:151], v[96:111]
    ds_read_b64 v[144:145], v10 offset:2144
    ds_read_b64 v[146:147], v10 offset:2152
    ds_read_b128 v[152:155], v12 offset:19648
    ds_read_b128 v[148:151], v12 offset:17088
    s_waitcnt lgkmcnt(12)
    v_mfma_f32_32x32x16_f16 v[112:127], v[160:163], v[168:171], v[112:127]
    v_mfma_f32_32x32x16_f16 v[96:111], v[160:163], v[164:167], v[96:111]
    ds_read_b64 v[160:161], v10 offset:2048
    ds_read_b64 v[162:163], v10 offset:2056
    ds_read_b128 v[168:171], v12 offset:19536
    ds_read_b128 v[164:167], v12 offset:16976
    s_waitcnt lgkmcnt(12)
    v_mfma_f32_32x32x16_f16 v[112:127], v[176:179], v[184:187], v[112:127]
    v_mfma_f32_32x32x16_f16 v[96:111], v[176:179], v[180:183], v[96:111]
    ds_read_b64 v[176:177], v10 offset:2080
    ds_read_b64 v[178:179], v10 offset:2088
    ds_read_b128 v[184:187], v12 offset:19568
    ds_read_b128 v[180:183], v12 offset:17008
    s_waitcnt lgkmcnt(12)
    v_mfma_f32_32x32x16_f16 v[112:127], v[128:131], v[136:139], v[112:127]
    v_mfma_f32_32x32x16_f16 v[96:111], v[128:131], v[132:135], v[96:111]
    ds_read_b64 v[128:129], v10 offset:1984
    ds_read_b64 v[130:131], v10 offset:1992
    ds_read_b128 v[136:139], v12 offset:19456
    ds_read_b128 v[132:135], v12 offset:16976
    s_waitcnt lgkmcnt(12)
    v_mfma_f32_32x32x16_f16 v[112:127], v[144:147], v[152:155], v[112:127]
    v_mfma_f32_32x32x16_f16 v[96:111], v[144:147], v[148:151], v[96:111]
    ds_read_b64 v[144:145], v10 offset:2016
    ds_read_b64 v[146:147], v10 offset:2024
    ds_read_b128 v[152:155], v12 offset:19488
    ds_read_b128 v[148:151], v12 offset:17008
    s_waitcnt lgkmcnt(12)
    v_mfma_f32_32x32x16_f16 v[112:127], v[160:163], v[168:171], v[112:127]
    v_mfma_f32_32x32x16_f16 v[96:111], v[160:163], v[164:167], v[96:111]
    ds_read_b64 v[160:161], v10 offset:1920
    ds_read_b64 v[162:163], v10 offset:1928
    ds_read_b128 v[168:171], v12 offset:19376
    ds_read_b128 v[164:167], v12 offset:16976
    s_waitcnt lgkmcnt(12)
    v_mfma_f32_32x32x16_f16 v[112:127], v[176:179], v[184:187], v[112:127]
    v_mfma_f32_32x32x16_f16 v[96:111], v[176:179], v[180:183], v[96:111]
    ds_read_b64 v[176:177], v10 offset:1952
    ds_read_b64 v[178:179], v10 offset:1960
    ds_read_b128 v[184:187], v12 offset:19408
    ds_read_b128 v[180:183], v12 offset:17008
    s_waitcnt lgkmcnt(12)
    v_mfma_f32_32x32x16_f16 v[112:127], v[128:131], v[136:139], v[112:127]
    ds_read_b64 v[128:129], v10 offset:1856
    ds_read_b64 v[130:131], v10 offset:1864
    ds_read_b128 v[136:139], v12 offset:19296
    ds_read_b128 v[132:135], v12 offset:16976
    s_waitcnt lgkmcnt(12)
    v_mfma_f32_32x32x16_f16 v[112:127], v[144:147], v[152:155], v[112:127]
    ds_read_b64 v[144:145], v10 offset:1888
    ds_read_b64 v[146:147], v10 offset:1896
    ds_read_b128 v[152:155], v12 offset:19328
    ds_read_b128 v[148:151], v12 offset:17008
    s_waitcnt lgkmcnt(12)
    v_mfma_f32_32x32x16_f16 v[112:127], v[160:163], v[168:171], v[112:127]
    ds_read_b64 v[160:161], v10 offset:1792
    ds_read_b64 v[162:163], v10 offset:1800
    ds_read_b128 v[168:171], v12 offset:19216
    ds_read_b128 v[164:167], v12 offset:16976
    s_waitcnt lgkmcnt(12)
    v_mfma_f32_32x32x16_f16 v[112:127], v[176:179], v[184:187], v[112:127]
    ds_read_b64 v[176:177], v10 offset:1824
    ds_read_b64 v[178:179], v10 offset:1832
    ds_read_b128 v[184:187], v12 offset:19248
    ds_read_b128 v[180:183], v12 offset:17008
    s_waitcnt lgkmcnt(12)
    v_mfma_f32_32x32x16_f16 v[112:127], v[128:131], v[136:139], v[112:127]
    ds_read_b64 v[128:129], v10 offset:1728
    ds_read_b64 v[130:131], v10 offset:1736
    ds_read_b128 v[136:139], v12 offset:19136
    ds_read_b128 v[132:135], v12 offset:16976
    s_waitcnt lgkmcnt(12)
    v_mfma_f32_32x32x16_f16 v[112:127], v[144:147], v[152:155], v[112:127]
    ds_read_b64 v[144:145], v10 offset:1760
    ds_read_b64 v[146:147], v10 offset:1768
    ds_read_b128 v[152:155], v12 offset:19168
    ds_read_b128 v[148:151], v12 offset:17008
    s_waitcnt lgkmcnt(12)
    v_mfma_f32_32x32x16_f16 v[112:127], v[160:163], v[168:171], v[112:127]
    ds_read_b64 v[160:161], v10 offset:1664
    ds_read_b64 v[162:163], v10 offset:1672
    ds_read_b128 v[168:171], v12 offset:19056
    ds_read_b128 v[164:167], v12 offset:16976
    s_waitcnt lgkmcnt(12)
    v_mfma_f32_32x32x16_f16 v[112:127], v[176:179], v[184:187], v[112:127]
    ds_read_b64 v[176:177], v10 offset:1696
    ds_read_b64 v[178:179], v10 offset:1704
    ds_read_b128 v[184:187], v12 offset:19088
    ds_read_b128 v[180:183], v12 offset:17008
    s_waitcnt lgkmcnt(12)
    v_mfma_f32_32x32x16_f16 v[112:127], v[128:131], v[136:139], v[112:127]
    ds_read_b64 v[128:129], v10 offset:1600
    ds_read_b64 v[130:131], v10 offset:1608
    ds_read_b128 v[136:139], v12 offset:18976
    ds_read_b128 v[132:135], v12 offset:16976
    s_waitcnt lgkmcnt(12)
    v_mfma_f32_32x32x16_f16 v[112:127], v[144:147], v[152:155], v[112:127]
    ds_read_b64 v[144:145], v10 offset:1632
    ds_read_b64 v[146:147], v10 offset:1640
    ds_read_b128 v[152:155], v12 offset:19008
    ds_read_b128 v[148:151], v12 offset:17008
    s_waitcnt lgkmcnt(12)
    v_mfma_f32_32x32x16_f16 v[112:127], v[160:163], v[168:171], v[112:127]
    ds_read_b64 v[160:161], v10 offset:1536
    ds_read_b64 v[162:163], v10 offset:1544
    ds_read_b128 v[168:171], v12 offset:18896
    ds_read_b128 v[164:167], v12 offset:16976
    s_waitcnt lgkmcnt(12)
    v_mfma_f32_32x32x16_f16 v[112:127], v[176:179], v[184:187], v[112:127]
    ds_read_b64 v[176:177], v10 offset:1568
    ds_read_b64 v[178:179], v10 offset:1576
    ds_read_b128 v[184:187], v12 offset:18928
    ds_read_b128 v[180:183], v12 offset:17008
    s_waitcnt lgkmcnt(12)
    v_mfma_f32_32x32x16_f16 v[112:127], v[128:131], v[136:139], v[112:127]
    ds_read_b64 v[128:129], v10 offset:1472
    ds_read_b64 v[130:131], v10 offset:1480
    ds_read_b128 v[136:139], v12 offset:18816
    ds_read_b128 v[132:135], v12 offset:16976
    s_waitcnt lgkmcnt(12)
    v_mfma_f32_32x32x16_f16 v[112:127], v[144:147], v[152:155], v[112:127]
    ds_read_b64 v[144:145], v10 offset:1504
    ds_read_b64 v[146:147], v10 offset:1512
    ds_read_b128 v[152:155], v12 offset:18848
    ds_read_b128 v[148:151], v12 offset:17008
    s_waitcnt lgkmcnt(12)
    v_mfma_f32_32x32x16_f16 v[112:127], v[160:163], v[168:171], v[112:127]
    ds_read_b64 v[160:161], v10 offset:1408
    ds_read_b64 v[162:163], v10 offset:1416
    ds_read_b128 v[168:171], v12 offset:18736
    ds_read_b128 v[164:167], v12 offset:16976
    s_waitcnt lgkmcnt(12)
    v_mfma_f32_32x32x16_f16 v[112:127], v[176:179], v[184:187], v[112:127]
    ds_read_b64 v[176:177], v10 offset:1440
    ds_read_b64 v[178:179], v10 offset:1448
    ds_read_b128 v[184:187], v12 offset:18768
    ds_read_b128 v[180:183], v12 offset:17008
    s_waitcnt lgkmcnt(12)
    v_mfma_f32_32x32x16_f16 v[112:127], v[128:131], v[136:139], v[112:127]
    ds_read_b64 v[128:129], v10 offset:1344
    ds_read_b64 v[130:131], v10 offset:1352
    ds_read_b128 v[136:139], v12 offset:18656
    ds_read_b128 v[132:135], v12 offset:16976
    s_waitcnt lgkmcnt(12)
    v_mfma_f32_32x32x16_f16 v[112:127], v[144:147], v[152:155], v[112:127]
    ds_read_b64 v[144:145], v10 offset:1376
    ds_read_b64 v[146:147], v10 offset:1384
    ds_read_b128 v[152:155], v12 offset:18688
    ds_read_b128 v[148:151], v12 offset:17008
    s_waitcnt lgkmcnt(12)
    v_mfma_f32_32x32x16_f16 v[112:127], v[160:163], v[168:171], v[112:127]
    ds_read_b64 v[160:161], v10 offset:1280
    ds_read_b64 v[162:163], v10 offset:1288
    ds_read_b128 v[168:171], v12 offset:18576
    ds_read_b128 v[164:167], v12 offset:16976
    s_waitcnt lgkmcnt(12)
    v_mfma_f32_32x32x16_f16 v[112:127], v[176:179], v[184:187], v[112:127]
    ds_read_b64 v[176:177], v10 offset:1312
    ds_read_b64 v[178:179], v10 offset:1320
    ds_read_b128 v[184:187], v12 offset:18608
    ds_read_b128 v[180:183], v12 offset:17008
    s_waitcnt lgkmcnt(12)
    v_mfma_f32_32x32x16_f16 v[112:127], v[128:131], v[136:139], v[112:127]
    ds_read_b64 v[128:129], v10 offset:1216
    ds_read_b64 v[130:131], v10 offset:1224
    ds_read_b128 v[136:139], v12 offset:18496
    ds_read_b128 v[132:135], v12 offset:16976
    s_waitcnt lgkmcnt(12)
    v_mfma_f32_32x32x16_f16 v[112:127], v[144:147], v[152:155], v[112:127]
    ds_read_b64 v[144:145], v10 offset:1248
    ds_read_b64 v[146:147], v10 offset:1256
    ds_read_b128 v[152:155], v12 offset:18528
    ds_read_b128 v[148:151], v12 offset:17008
    s_waitcnt lgkmcnt(12)
    v_mfma_f32_32x32x16_f16 v[112:127], v[160:163], v[168:171], v[112:127]
    ds_read_b64 v[160:161], v10 offset:1152
    ds_read_b64 v[162:163], v10 offset:1160
    ds_read_b128 v[168:171], v12 offset:18416
    ds_read_b128 v[164:167], v12 offset:16976
    s_waitcnt lgkmcnt(12)
    v_mfma_f32_32x32x16_f16 v[112:127], v[176:179], v[184:187], v[112:127]
    ds_read_b64 v[176:177], v10 offset:1184
    ds_read_b64 v[178:179], v10 offset:1192
    ds_read_b128 v[184:187], v12 offset:18448
    ds_read_b128 v[180:183], v12 offset:17008
    s_waitcnt lgkmcnt(12)
    v_mfma_f32_32x32x16_f16 v[112:127], v[128:131], v[136:139], v[112:127]
    ds_read_b64 v[128:129], v10 offset:1088
    ds_read_b64 v[130:131], v10 offset:1096
    ds_read_b128 v[136:139], v12 offset:18336
    ds_read_b128 v[132:135], v12 offset:16976
    s_waitcnt lgkmcnt(12)
    v_mfma_f32_32x32x16_f16 v[112:127], v[144:147], v[152:155], v[112:127]
    ds_read_b64 v[144:145], v10 offset:1120
    ds_read_b64 v[146:147], v10 offset:1128
    ds_read_b128 v[152:155], v12 offset:18368
    ds_read_b128 v[148:151], v12 offset:17008
    s_waitcnt lgkmcnt(12)
    v_mfma_f32_32x32x16_f16 v[112:127], v[160:163], v[168:171], v[112:127]
    ds_read_b64 v[160:161], v10 offset:1024
    ds_read_b64 v[162:163], v10 offset:1032
    ds_read_b128 v[168:171], v12 offset:18256
    ds_read_b128 v[164:167], v12 offset:16976
    s_waitcnt lgkmcnt(12)
    v_mfma_f32_32x32x16_f16 v[112:127], v[176:179], v[184:187], v[112:127]
    ds_read_b64 v[176:177], v10 offset:1056
    ds_read_b64 v[178:179], v10 offset:1064
    ds_read_b128 v[184:187], v12 offset:18288
    ds_read_b128 v[180:183], v12 offset:17008
    s_waitcnt lgkmcnt(12)
    v_mfma_f32_32x32x16_f16 v[112:127], v[128:131], v[136:139], v[112:127]
    ds_read_b64 v[128:129], v10 offset:960
    ds_read_b64 v[130:131], v10 offset:968
    ds_read_b128 v[136:139], v12 offset:18176
    ds_read_b128 v[132:135], v12 offset:16976
    s_waitcnt lgkmcnt(12)
    v_mfma_f32_32x32x16_f16 v[112:127], v[144:147], v[152:155], v[112:127]
    ds_read_b64 v[144:145], v10 offset:992
    ds_read_b64 v[146:147], v10 offset:1000
    ds_read_b128 v[152:155], v12 offset:18208
    ds_read_b128 v[148:151], v12 offset:17008
    s_waitcnt lgkmcnt(12)
    v_mfma_f32_32x32x16_f16 v[112:127], v[160:163], v[168:171], v[112:127]
    ds_read_b64 v[160:161], v10 offset:896
    ds_read_b64 v[162:163], v10 offset:904
    ds_read_b128 v[168:171], v12 offset:18096
    ds_read_b128 v[164:167], v12 offset:16976
    s_waitcnt lgkmcnt(12)
    v_mfma_f32_32x32x16_f16 v[112:127], v[176:179], v[184:187], v[112:127]
    ds_read_b64 v[176:177], v10 offset:928
    ds_read_b64 v[178:179], v10 offset:936
    ds_read_b128 v[184:187], v12 offset:18128
    ds_read_b128 v[180:183], v12 offset:17008
    s_waitcnt lgkmcnt(12)
    v_mfma_f32_32x32x16_f16 v[112:127], v[128:131], v[136:139], v[112:127]
    ds_read_b64 v[128:129], v10 offset:832
    ds_read_b64 v[130:131], v10 offset:840
    ds_read_b128 v[136:139], v12 offset:18016
    ds_read_b128 v[132:135], v12 offset:16976
    s_waitcnt lgkmcnt(12)
    v_mfma_f32_32x32x16_f16 v[112:127], v[144:147], v[152:155], v[112:127]
    ds_read_b64 v[144:145], v10 offset:864
    ds_read_b64 v[146:147], v10 offset:872
    ds_read_b128 v[152:155], v12 offset:18048
    ds_read_b128 v[148:151], v12 offset:17008
    s_waitcnt lgkmcnt(12)
    v_mfma_f32_32x32x16_f16 v[112:127], v[160:163], v[168:171], v[112:127]
    ds_read_b64 v[160:161], v10 offset:768
    ds_read_b64 v[162:163], v10 offset:776
    ds_read_b128 v[168:171], v12 offset:17936
    ds_read_b128 v[164:167], v12 offset:16976
    s_waitcnt lgkmcnt(12)
    v_mfma_f32_32x32x16_f16 v[112:127], v[176:179], v[184:187], v[112:127]
    ds_read_b64 v[176:177], v10 offset:800
    ds_read_b64 v[178:179], v10 offset:808
    ds_read_b128 v[184:187], v12 offset:17968
    ds_read_b128 v[180:183], v12 offset:17008
    s_waitcnt lgkmcnt(12)
    v_mfma_f32_32x32x16_f16 v[112:127], v[128:131], v[136:139], v[112:127]
    ds_read_b64 v[128:129], v10 offset:704
    ds_read_b64 v[130:131], v10 offset:712
    ds_read_b128 v[136:139], v12 offset:17856
    ds_read_b128 v[132:135], v12 offset:16976
    s_waitcnt lgkmcnt(12)
    v_mfma_f32_32x32x16_f16 v[112:127], v[144:147], v[152:155], v[112:127]
    ds_read_b64 v[144:145], v10 offset:736
    ds_read_b64 v[146:147], v10 offset:744
    ds_read_b128 v[152:155], v12 offset:17888
    ds_read_b128 v[148:151], v12 offset:17008
    s_waitcnt lgkmcnt(12)
    v_mfma_f32_32x32x16_f16 v[112:127], v[160:163], v[168:171], v[112:127]
    ds_read_b64 v[160:161], v10 offset:640
    ds_read_b64 v[162:163], v10 offset:648
    ds_read_b128 v[168:171], v12 offset:17776
    ds_read_b128 v[164:167], v12 offset:16976
    s_waitcnt lgkmcnt(12)
    v_mfma_f32_32x32x16_f16 v[112:127], v[176:179], v[184:187], v[112:127]
    ds_read_b64 v[176:177], v10 offset:672
    ds_read_b64 v[178:179], v10 offset:680
    ds_read_b128 v[184:187], v12 offset:17808
    ds_read_b128 v[180:183], v12 offset:17008
    s_waitcnt lgkmcnt(12)
    v_mfma_f32_32x32x16_f16 v[112:127], v[128:131], v[136:139], v[112:127]
    ds_read_b64 v[128:129], v10 offset:576
    ds_read_b64 v[130:131], v10 offset:584
    ds_read_b128 v[136:139], v12 offset:17696
    ds_read_b128 v[132:135], v12 offset:16976
    s_waitcnt lgkmcnt(12)
    v_mfma_f32_32x32x16_f16 v[112:127], v[144:147], v[152:155], v[112:127]
    ds_read_b64 v[144:145], v10 offset:608
    ds_read_b64 v[146:147], v10 offset:616
    ds_read_b128 v[152:155], v12 offset:17728
    ds_read_b128 v[148:151], v12 offset:17008
    s_waitcnt lgkmcnt(12)
    v_mfma_f32_32x32x16_f16 v[112:127], v[160:163], v[168:171], v[112:127]
    ds_read_b64 v[160:161], v10 offset:512
    ds_read_b64 v[162:163], v10 offset:520
    ds_read_b128 v[168:171], v12 offset:17616
    ds_read_b128 v[164:167], v12 offset:16976
    s_waitcnt lgkmcnt(12)
    v_mfma_f32_32x32x16_f16 v[112:127], v[176:179], v[184:187], v[112:127]
    ds_read_b64 v[176:177], v10 offset:544
    ds_read_b64 v[178:179], v10 offset:552
    ds_read_b128 v[184:187], v12 offset:17648
    ds_read_b128 v[180:183], v12 offset:17008
    s_waitcnt lgkmcnt(12)
    v_mfma_f32_32x32x16_f16 v[112:127], v[128:131], v[136:139], v[112:127]
    ds_read_b64 v[128:129], v10 offset:448
    ds_read_b64 v[130:131], v10 offset:456
    ds_read_b128 v[136:139], v12 offset:17536
    ds_read_b128 v[132:135], v12 offset:16976
    s_waitcnt lgkmcnt(12)
    v_mfma_f32_32x32x16_f16 v[112:127], v[144:147], v[152:155], v[112:127]
    ds_read_b64 v[144:145], v10 offset:480
    ds_read_b64 v[146:147], v10 offset:488
    ds_read_b128 v[152:155], v12 offset:17568
    ds_read_b128 v[148:151], v12 offset:17008
    s_waitcnt lgkmcnt(12)
    v_mfma_f32_32x32x16_f16 v[112:127], v[160:163], v[168:171], v[112:127]
    ds_read_b64 v[160:161], v10 offset:384
    ds_read_b64 v[162:163], v10 offset:392
    ds_read_b128 v[168:171], v12 offset:17456
    ds_read_b128 v[164:167], v12 offset:16976
    s_waitcnt lgkmcnt(12)
    v_mfma_f32_32x32x16_f16 v[112:127], v[176:179], v[184:187], v[112:127]
    ds_read_b64 v[176:177], v10 offset:416
    ds_read_b64 v[178:179], v10 offset:424
    ds_read_b128 v[184:187], v12 offset:17488
    ds_read_b128 v[180:183], v12 offset:17008
    s_waitcnt lgkmcnt(12)
    v_mfma_f32_32x32x16_f16 v[112:127], v[128:131], v[136:139], v[112:127]
    ds_read_b64 v[128:129], v10 offset:320
    ds_read_b64 v[130:131], v10 offset:328
    ds_read_b128 v[136:139], v12 offset:17376
    ds_read_b128 v[132:135], v12 offset:16976
    s_waitcnt lgkmcnt(12)
    v_mfma_f32_32x32x16_f16 v[112:127], v[144:147], v[152:155], v[112:127]
    ds_read_b64 v[144:145], v10 offset:352
    ds_read_b64 v[146:147], v10 offset:360
    ds_read_b128 v[152:155], v12 offset:17408
    ds_read_b128 v[148:151], v12 offset:17008
    s_waitcnt lgkmcnt(12)
    v_mfma_f32_32x32x16_f16 v[112:127], v[160:163], v[168:171], v[112:127]
    ds_read_b64 v[160:161], v10 offset:256
    ds_read_b64 v[162:163], v10 offset:264
    ds_read_b128 v[168:171], v12 offset:17296
    ds_read_b128 v[164:167], v12 offset:16976
    s_waitcnt lgkmcnt(12)
    v_mfma_f32_32x32x16_f16 v[112:127], v[176:179], v[184:187], v[112:127]
    ds_read_b64 v[176:177], v10 offset:288
    ds_read_b64 v[178:179], v10 offset:296
    ds_read_b128 v[184:187], v12 offset:17328
    ds_read_b128 v[180:183], v12 offset:17008
    s_waitcnt lgkmcnt(12)
    v_mfma_f32_32x32x16_f16 v[112:127], v[128:131], v[136:139], v[112:127]
    ds_read_b64 v[128:129], v10 offset:192
    ds_read_b64 v[130:131], v10 offset:200
    ds_read_b128 v[136:139], v12 offset:17216
    ds_read_b128 v[132:135], v12 offset:16976
    s_waitcnt lgkmcnt(12)
    v_mfma_f32_32x32x16_f16 v[112:127], v[144:147], v[152:155], v[112:127]
    ds_read_b64 v[144:145], v10 offset:224
    ds_read_b64 v[146:147], v10 offset:232
    ds_read_b128 v[152:155], v12 offset:17248
    ds_read_b128 v[148:151], v12 offset:17008
    s_waitcnt lgkmcnt(12)
    v_mfma_f32_32x32x16_f16 v[112:127], v[160:163], v[168:171], v[112:127]
    ds_read_b64 v[160:161], v10 offset:128
    ds_read_b64 v[162:163], v10 offset:136
    ds_read_b128 v[168:171], v12 offset:17136
    ds_read_b128 v[164:167], v12 offset:16976
    s_waitcnt lgkmcnt(12)
    v_mfma_f32_32x32x16_f16 v[112:127], v[176:179], v[184:187], v[112:127]
    ds_read_b64 v[176:177], v10 offset:160
    ds_read_b64 v[178:179], v10 offset:168
    ds_read_b128 v[184:187], v12 offset:17168
    ds_read_b128 v[180:183], v12 offset:17008
    s_waitcnt lgkmcnt(12)
    v_mfma_f32_32x32x16_f16 v[112:127], v[128:131], v[136:139], v[112:127]
    ds_read_b64 v[128:129], v10 offset:64
    ds_read_b64 v[130:131], v10 offset:72
    ds_read_b128 v[136:139], v12 offset:17056
    ds_read_b128 v[132:135], v12 offset:16976
    s_waitcnt lgkmcnt(12)
    v_mfma_f32_32x32x16_f16 v[112:127], v[144:147], v[152:155], v[112:127]
    ds_read_b64 v[144:145], v10 offset:96
    ds_read_b64 v[146:147], v10 offset:104
    ds_read_b128 v[152:155], v12 offset:17088
    ds_read_b128 v[148:151], v12 offset:17008
    s_waitcnt lgkmcnt(12)
    v_mfma_f32_32x32x16_f16 v[112:127], v[160:163], v[168:171], v[112:127]
    ds_read_b64 v[160:161], v10 offset:0
    ds_read_b64 v[162:163], v10 offset:8
    ds_read_b128 v[168:171], v12 offset:16976
    ds_read_b128 v[164:167], v12 offset:16976
    s_waitcnt lgkmcnt(12)
    v_mfma_f32_32x32x16_f16 v[112:127], v[176:179], v[184:187], v[112:127]
    ds_read_b64 v[176:177], v10 offset:32
    ds_read_b64 v[178:179], v10 offset:40
    ds_read_b128 v[184:187], v12 offset:17008
    ds_read_b128 v[180:183], v12 offset:17008
    s_waitcnt lgkmcnt(12)
    v_mfma_f32_32x32x16_f16 v[112:127], v[128:131], v[136:139], v[112:127]
    s_waitcnt lgkmcnt(8)
    v_mfma_f32_32x32x16_f16 v[112:127], v[144:147], v[152:155], v[112:127]
    s_waitcnt lgkmcnt(4)
    v_mfma_f32_32x32x16_f16 v[112:127], v[160:163], v[168:171], v[112:127]
    s_waitcnt lgkmcnt(0)
    v_mfma_f32_32x32x16_f16 v[112:127], v[176:179], v[184:187], v[112:127]
    s_nop 15
    v_lshlrev_b32 v60, 16, v60
    v_lshlrev_b32 v14, 6, v8
    v_lshlrev_b32 v15, 3, v9
    v_add_u32 v14, v14, v15
    v_mul_u32_u24 v12, 80, v8
    v_add_u32 v12, v12, v15
    v_add_u32 v12, s62, v12
    ds_read_b64 v[16:17], v12 offset:19456
    s_waitcnt lgkmcnt(0)
    v_cvt_f32_f16 v20, v16
    v_lshrrev_b32 v16, 16, v16
    v_cvt_f32_f16 v21, v16
    v_cvt_f32_f16 v22, v17
    v_lshrrev_b32 v17, 16, v17
    v_cvt_f32_f16 v23, v17
    v_mul_f32 v20, v20, v60
    v_cvt_pk_bf16_f32 v20, v20, v20
    v_lshlrev_b32 v20, 16, v20
    v_cvt_pk_bf16_f32 v96, v96, v96
    v_lshlrev_b32 v96, 16, v96
    v_add_f32 v20, v20, v96
    v_mul_f32 v21, v21, v60
    v_cvt_pk_bf16_f32 v21, v21, v21
    v_lshlrev_b32 v21, 16, v21
    v_cvt_pk_bf16_f32 v97, v97, v97
    v_lshlrev_b32 v97, 16, v97
    v_add_f32 v21, v21, v97
    v_mul_f32 v22, v22, v60
    v_cvt_pk_bf16_f32 v22, v22, v22
    v_lshlrev_b32 v22, 16, v22
    v_cvt_pk_bf16_f32 v98, v98, v98
    v_lshlrev_b32 v98, 16, v98
    v_add_f32 v22, v22, v98
    v_mul_f32 v23, v23, v60
    v_cvt_pk_bf16_f32 v23, v23, v23
    v_lshlrev_b32 v23, 16, v23
    v_cvt_pk_bf16_f32 v99, v99, v99
    v_lshlrev_b32 v99, 16, v99
    v_add_f32 v23, v23, v99
    v_cvt_pk_bf16_f32 v24, v20, v21
    v_cvt_pk_bf16_f32 v25, v22, v23
    buffer_store_dwordx2 v[24:25], v14, s[44:47], s63 offen offset:0
    ds_read_b64 v[16:17], v12 offset:19472
    s_waitcnt lgkmcnt(0)
    v_cvt_f32_f16 v20, v16
    v_lshrrev_b32 v16, 16, v16
    v_cvt_f32_f16 v21, v16
    v_cvt_f32_f16 v22, v17
    v_lshrrev_b32 v17, 16, v17
    v_cvt_f32_f16 v23, v17
    v_mul_f32 v20, v20, v60
    v_cvt_pk_bf16_f32 v20, v20, v20
    v_lshlrev_b32 v20, 16, v20
    v_cvt_pk_bf16_f32 v100, v100, v100
    v_lshlrev_b32 v100, 16, v100
    v_add_f32 v20, v20, v100
    v_mul_f32 v21, v21, v60
    v_cvt_pk_bf16_f32 v21, v21, v21
    v_lshlrev_b32 v21, 16, v21
    v_cvt_pk_bf16_f32 v101, v101, v101
    v_lshlrev_b32 v101, 16, v101
    v_add_f32 v21, v21, v101
    v_mul_f32 v22, v22, v60
    v_cvt_pk_bf16_f32 v22, v22, v22
    v_lshlrev_b32 v22, 16, v22
    v_cvt_pk_bf16_f32 v102, v102, v102
    v_lshlrev_b32 v102, 16, v102
    v_add_f32 v22, v22, v102
    v_mul_f32 v23, v23, v60
    v_cvt_pk_bf16_f32 v23, v23, v23
    v_lshlrev_b32 v23, 16, v23
    v_cvt_pk_bf16_f32 v103, v103, v103
    v_lshlrev_b32 v103, 16, v103
    v_add_f32 v23, v23, v103
    v_cvt_pk_bf16_f32 v24, v20, v21
    v_cvt_pk_bf16_f32 v25, v22, v23
    buffer_store_dwordx2 v[24:25], v14, s[44:47], s63 offen offset:16
    ds_read_b64 v[16:17], v12 offset:19488
    s_waitcnt lgkmcnt(0)
    v_cvt_f32_f16 v20, v16
    v_lshrrev_b32 v16, 16, v16
    v_cvt_f32_f16 v21, v16
    v_cvt_f32_f16 v22, v17
    v_lshrrev_b32 v17, 16, v17
    v_cvt_f32_f16 v23, v17
    v_mul_f32 v20, v20, v60
    v_cvt_pk_bf16_f32 v20, v20, v20
    v_lshlrev_b32 v20, 16, v20
    v_cvt_pk_bf16_f32 v104, v104, v104
    v_lshlrev_b32 v104, 16, v104
    v_add_f32 v20, v20, v104
    v_mul_f32 v21, v21, v60
    v_cvt_pk_bf16_f32 v21, v21, v21
    v_lshlrev_b32 v21, 16, v21
    v_cvt_pk_bf16_f32 v105, v105, v105
    v_lshlrev_b32 v105, 16, v105
    v_add_f32 v21, v21, v105
    v_mul_f32 v22, v22, v60
    v_cvt_pk_bf16_f32 v22, v22, v22
    v_lshlrev_b32 v22, 16, v22
    v_cvt_pk_bf16_f32 v106, v106, v106
    v_lshlrev_b32 v106, 16, v106
    v_add_f32 v22, v22, v106
    v_mul_f32 v23, v23, v60
    v_cvt_pk_bf16_f32 v23, v23, v23
    v_lshlrev_b32 v23, 16, v23
    v_cvt_pk_bf16_f32 v107, v107, v107
    v_lshlrev_b32 v107, 16, v107
    v_add_f32 v23, v23, v107
    v_cvt_pk_bf16_f32 v24, v20, v21
    v_cvt_pk_bf16_f32 v25, v22, v23
    buffer_store_dwordx2 v[24:25], v14, s[44:47], s63 offen offset:32
    ds_read_b64 v[16:17], v12 offset:19504
    s_waitcnt lgkmcnt(0)
    v_cvt_f32_f16 v20, v16
    v_lshrrev_b32 v16, 16, v16
    v_cvt_f32_f16 v21, v16
    v_cvt_f32_f16 v22, v17
    v_lshrrev_b32 v17, 16, v17
    v_cvt_f32_f16 v23, v17
    v_mul_f32 v20, v20, v60
    v_cvt_pk_bf16_f32 v20, v20, v20
    v_lshlrev_b32 v20, 16, v20
    v_cvt_pk_bf16_f32 v108, v108, v108
    v_lshlrev_b32 v108, 16, v108
    v_add_f32 v20, v20, v108
    v_mul_f32 v21, v21, v60
    v_cvt_pk_bf16_f32 v21, v21, v21
    v_lshlrev_b32 v21, 16, v21
    v_cvt_pk_bf16_f32 v109, v109, v109
    v_lshlrev_b32 v109, 16, v109
    v_add_f32 v21, v21, v109
    v_mul_f32 v22, v22, v60
    v_cvt_pk_bf16_f32 v22, v22, v22
    v_lshlrev_b32 v22, 16, v22
    v_cvt_pk_bf16_f32 v110, v110, v110
    v_lshlrev_b32 v110, 16, v110
    v_add_f32 v22, v22, v110
    v_mul_f32 v23, v23, v60
    v_cvt_pk_bf16_f32 v23, v23, v23
    v_lshlrev_b32 v23, 16, v23
    v_cvt_pk_bf16_f32 v111, v111, v111
    v_lshlrev_b32 v111, 16, v111
    v_add_f32 v23, v23, v111
    v_cvt_pk_bf16_f32 v24, v20, v21
    v_cvt_pk_bf16_f32 v25, v22, v23
    buffer_store_dwordx2 v[24:25], v14, s[44:47], s63 offen offset:48
    ds_read_b64 v[16:17], v12 offset:22016
    s_waitcnt lgkmcnt(0)
    v_cvt_f32_f16 v20, v16
    v_lshrrev_b32 v16, 16, v16
    v_cvt_f32_f16 v21, v16
    v_cvt_f32_f16 v22, v17
    v_lshrrev_b32 v17, 16, v17
    v_cvt_f32_f16 v23, v17
    v_mul_f32 v20, v20, v60
    v_cvt_pk_bf16_f32 v20, v20, v20
    v_lshlrev_b32 v20, 16, v20
    v_cvt_pk_bf16_f32 v112, v112, v112
    v_lshlrev_b32 v112, 16, v112
    v_add_f32 v20, v20, v112
    v_mul_f32 v21, v21, v60
    v_cvt_pk_bf16_f32 v21, v21, v21
    v_lshlrev_b32 v21, 16, v21
    v_cvt_pk_bf16_f32 v113, v113, v113
    v_lshlrev_b32 v113, 16, v113
    v_add_f32 v21, v21, v113
    v_mul_f32 v22, v22, v60
    v_cvt_pk_bf16_f32 v22, v22, v22
    v_lshlrev_b32 v22, 16, v22
    v_cvt_pk_bf16_f32 v114, v114, v114
    v_lshlrev_b32 v114, 16, v114
    v_add_f32 v22, v22, v114
    v_mul_f32 v23, v23, v60
    v_cvt_pk_bf16_f32 v23, v23, v23
    v_lshlrev_b32 v23, 16, v23
    v_cvt_pk_bf16_f32 v115, v115, v115
    v_lshlrev_b32 v115, 16, v115
    v_add_f32 v23, v23, v115
    v_cvt_pk_bf16_f32 v24, v20, v21
    v_cvt_pk_bf16_f32 v25, v22, v23
    buffer_store_dwordx2 v[24:25], v14, s[44:47], s63 offen offset:2048
    ds_read_b64 v[16:17], v12 offset:22032
    s_waitcnt lgkmcnt(0)
    v_cvt_f32_f16 v20, v16
    v_lshrrev_b32 v16, 16, v16
    v_cvt_f32_f16 v21, v16
    v_cvt_f32_f16 v22, v17
    v_lshrrev_b32 v17, 16, v17
    v_cvt_f32_f16 v23, v17
    v_mul_f32 v20, v20, v60
    v_cvt_pk_bf16_f32 v20, v20, v20
    v_lshlrev_b32 v20, 16, v20
    v_cvt_pk_bf16_f32 v116, v116, v116
    v_lshlrev_b32 v116, 16, v116
    v_add_f32 v20, v20, v116
    v_mul_f32 v21, v21, v60
    v_cvt_pk_bf16_f32 v21, v21, v21
    v_lshlrev_b32 v21, 16, v21
    v_cvt_pk_bf16_f32 v117, v117, v117
    v_lshlrev_b32 v117, 16, v117
    v_add_f32 v21, v21, v117
    v_mul_f32 v22, v22, v60
    v_cvt_pk_bf16_f32 v22, v22, v22
    v_lshlrev_b32 v22, 16, v22
    v_cvt_pk_bf16_f32 v118, v118, v118
    v_lshlrev_b32 v118, 16, v118
    v_add_f32 v22, v22, v118
    v_mul_f32 v23, v23, v60
    v_cvt_pk_bf16_f32 v23, v23, v23
    v_lshlrev_b32 v23, 16, v23
    v_cvt_pk_bf16_f32 v119, v119, v119
    v_lshlrev_b32 v119, 16, v119
    v_add_f32 v23, v23, v119
    v_cvt_pk_bf16_f32 v24, v20, v21
    v_cvt_pk_bf16_f32 v25, v22, v23
    buffer_store_dwordx2 v[24:25], v14, s[44:47], s63 offen offset:2064
    ds_read_b64 v[16:17], v12 offset:22048
    s_waitcnt lgkmcnt(0)
    v_cvt_f32_f16 v20, v16
    v_lshrrev_b32 v16, 16, v16
    v_cvt_f32_f16 v21, v16
    v_cvt_f32_f16 v22, v17
    v_lshrrev_b32 v17, 16, v17
    v_cvt_f32_f16 v23, v17
    v_mul_f32 v20, v20, v60
    v_cvt_pk_bf16_f32 v20, v20, v20
    v_lshlrev_b32 v20, 16, v20
    v_cvt_pk_bf16_f32 v120, v120, v120
    v_lshlrev_b32 v120, 16, v120
    v_add_f32 v20, v20, v120
    v_mul_f32 v21, v21, v60
    v_cvt_pk_bf16_f32 v21, v21, v21
    v_lshlrev_b32 v21, 16, v21
    v_cvt_pk_bf16_f32 v121, v121, v121
    v_lshlrev_b32 v121, 16, v121
    v_add_f32 v21, v21, v121
    v_mul_f32 v22, v22, v60
    v_cvt_pk_bf16_f32 v22, v22, v22
    v_lshlrev_b32 v22, 16, v22
    v_cvt_pk_bf16_f32 v122, v122, v122
    v_lshlrev_b32 v122, 16, v122
    v_add_f32 v22, v22, v122
    v_mul_f32 v23, v23, v60
    v_cvt_pk_bf16_f32 v23, v23, v23
    v_lshlrev_b32 v23, 16, v23
    v_cvt_pk_bf16_f32 v123, v123, v123
    v_lshlrev_b32 v123, 16, v123
    v_add_f32 v23, v23, v123
    v_cvt_pk_bf16_f32 v24, v20, v21
    v_cvt_pk_bf16_f32 v25, v22, v23
    buffer_store_dwordx2 v[24:25], v14, s[44:47], s63 offen offset:2080
    ds_read_b64 v[16:17], v12 offset:22064
    s_waitcnt lgkmcnt(0)
    v_cvt_f32_f16 v20, v16
    v_lshrrev_b32 v16, 16, v16
    v_cvt_f32_f16 v21, v16
    v_cvt_f32_f16 v22, v17
    v_lshrrev_b32 v17, 16, v17
    v_cvt_f32_f16 v23, v17
    v_mul_f32 v20, v20, v60
    v_cvt_pk_bf16_f32 v20, v20, v20
    v_lshlrev_b32 v20, 16, v20
    v_cvt_pk_bf16_f32 v124, v124, v124
    v_lshlrev_b32 v124, 16, v124
    v_add_f32 v20, v20, v124
    v_mul_f32 v21, v21, v60
    v_cvt_pk_bf16_f32 v21, v21, v21
    v_lshlrev_b32 v21, 16, v21
    v_cvt_pk_bf16_f32 v125, v125, v125
    v_lshlrev_b32 v125, 16, v125
    v_add_f32 v21, v21, v125
    v_mul_f32 v22, v22, v60
    v_cvt_pk_bf16_f32 v22, v22, v22
    v_lshlrev_b32 v22, 16, v22
    v_cvt_pk_bf16_f32 v126, v126, v126
    v_lshlrev_b32 v126, 16, v126
    v_add_f32 v22, v22, v126
    v_mul_f32 v23, v23, v60
    v_cvt_pk_bf16_f32 v23, v23, v23
    v_lshlrev_b32 v23, 16, v23
    v_cvt_pk_bf16_f32 v127, v127, v127
    v_lshlrev_b32 v127, 16, v127
    v_add_f32 v23, v23, v127
    v_cvt_pk_bf16_f32 v24, v20, v21
    v_cvt_pk_bf16_f32 v25, v22, v23
    buffer_store_dwordx2 v[24:25], v14, s[44:47], s63 offen offset:2096
    s_endpgm
M_G1:
    s_add_u32 s36, s32, 0x400000
    s_addc_u32 s37, s33, 0
    s_mov_b32 s38, 0x188000
    s_mov_b32 s39, 0x00020000
    s_mov_b32 s40, s32
    s_mov_b32 s41, s33
    s_mov_b32 s42, 0x1c0000
    s_mov_b32 s43, 0x00020000
    s_add_u32 s44, s32, 0xa00000
    s_addc_u32 s45, s33, 0
    s_mov_b32 s46, 0x700000
    s_mov_b32 s47, 0x00020000
    s_mov_b32 s48, s22
    s_mov_b32 s49, s23
    s_mov_b32 s50, 0xe00
    s_mov_b32 s51, 0x00020000
    s_sub_u32 s60, s2, 112
    s_mul_hi_u32 s61, s60, 0x12492493
    s_mul_i32 s62, s61, 14
    s_sub_u32 s62, s60, s62
    v_and_b32 v1, 63, v0
    v_lshrrev_b32 v2, 6, v0
    s_nop 0
    v_readfirstlane_b32 s63, v2
    s_and_b32 s64, s63, 1
    s_lshr_b32 s65, s63, 1
    s_lshl_b32 s66, s62, 2
    s_lshl_b32 s64, s64, 1
    s_add_u32 s66, s66, s64
    s_lshl_b32 s67, s61, 2
    s_lshl_b32 s65, s65, 1
    s_add_u32 s67, s67, s65
    v_lshlrev_b32 v3, 4, v1
    s_mul_i32 s68, s66, 28672
    v_add_u32 v4, s68, v3
    v_add_u32 v5, 28672, v4
    s_mul_i32 s68, s67, 28672
    v_add_u32 v6, s68, v3
    v_add_u32 v7, 28672, v6
    v_mov_b32 v64, 0
    v_mov_b32 v65, 0
    v_mov_b32 v66, 0
    v_mov_b32 v67, 0
    v_mov_b32 v68, 0
    v_mov_b32 v69, 0
    v_mov_b32 v70, 0
    v_mov_b32 v71, 0
    v_mov_b32 v72, 0
    v_mov_b32 v73, 0
    v_mov_b32 v74, 0
    v_mov_b32 v75, 0
    v_mov_b32 v76, 0
    v_mov_b32 v77, 0
    v_mov_b32 v78, 0
    v_mov_b32 v79, 0
    v_mov_b32 v80, 0
    v_mov_b32 v81, 0
    v_mov_b32 v82, 0
    v_mov_b32 v83, 0
    v_mov_b32 v84, 0
    v_mov_b32 v85, 0
    v_mov_b32 v86, 0
    v_mov_b32 v87, 0
    v_mov_b32 v88, 0
    v_mov_b32 v89, 0
    v_mov_b32 v90, 0
    v_mov_b32 v91, 0
    v_mov_b32 v92, 0
    v_mov_b32 v93, 0
    v_mov_b32 v94, 0
    v_mov_b32 v95, 0
    v_mov_b32 v96, 0
    v_mov_b32 v97, 0
    v_mov_b32 v98, 0
    v_mov_b32 v99, 0
    v_mov_b32 v100, 0
    v_mov_b32 v101, 0
    v_mov_b32 v102, 0
    v_mov_b32 v103, 0
    v_mov_b32 v104, 0
    v_mov_b32 v105, 0
    v_mov_b32 v106, 0
    v_mov_b32 v107, 0
    v_mov_b32 v108, 0
    v_mov_b32 v109, 0
    v_mov_b32 v110, 0
    v_mov_b32 v111, 0
    v_mov_b32 v112, 0
    v_mov_b32 v113, 0
    v_mov_b32 v114, 0
    v_mov_b32 v115, 0
    v_mov_b32 v116, 0
    v_mov_b32 v117, 0
    v_mov_b32 v118, 0
    v_mov_b32 v119, 0
    v_mov_b32 v120, 0
    v_mov_b32 v121, 0
    v_mov_b32 v122, 0
    v_mov_b32 v123, 0
    v_mov_b32 v124, 0
    v_mov_b32 v125, 0
    v_mov_b32 v126, 0
    v_mov_b32 v127, 0
    s_mov_b32 s70, 0
    buffer_load_dwordx4 v[128:131], v4, s[36:39], s70 offen
    buffer_load_dwordx4 v[132:135], v5, s[36:39], s70 offen
    buffer_load_dwordx4 v[136:139], v6, s[40:43], s70 offen
    buffer_load_dwordx4 v[140:143], v7, s[40:43], s70 offen
    s_mov_b32 s70, 1024
    buffer_load_dwordx4 v[144:147], v4, s[36:39], s70 offen
    buffer_load_dwordx4 v[148:151], v5, s[36:39], s70 offen
    buffer_load_dwordx4 v[152:155], v6, s[40:43], s70 offen
    buffer_load_dwordx4 v[156:159], v7, s[40:43], s70 offen
    s_mov_b32 s70, 2048
    buffer_load_dwordx4 v[160:163], v4, s[36:39], s70 offen
    buffer_load_dwordx4 v[164:167], v5, s[36:39], s70 offen
    buffer_load_dwordx4 v[168:171], v6, s[40:43], s70 offen
    buffer_load_dwordx4 v[172:175], v7, s[40:43], s70 offen
    s_mov_b32 s70, 3072
    buffer_load_dwordx4 v[176:179], v4, s[36:39], s70 offen
    buffer_load_dwordx4 v[180:183], v5, s[36:39], s70 offen
    buffer_load_dwordx4 v[184:187], v6, s[40:43], s70 offen
    buffer_load_dwordx4 v[188:191], v7, s[40:43], s70 offen
    s_mov_b32 s70, 4096
    buffer_load_dwordx4 v[192:195], v4, s[36:39], s70 offen
    buffer_load_dwordx4 v[196:199], v5, s[36:39], s70 offen
    buffer_load_dwordx4 v[200:203], v6, s[40:43], s70 offen
    buffer_load_dwordx4 v[204:207], v7, s[40:43], s70 offen
    s_mov_b32 s70, 5120
    buffer_load_dwordx4 v[208:211], v4, s[36:39], s70 offen
    buffer_load_dwordx4 v[212:215], v5, s[36:39], s70 offen
    buffer_load_dwordx4 v[216:219], v6, s[40:43], s70 offen
    buffer_load_dwordx4 v[220:223], v7, s[40:43], s70 offen
    s_mov_b32 s70, 6144
    buffer_load_dwordx4 v[224:227], v4, s[36:39], s70 offen
    buffer_load_dwordx4 v[228:231], v5, s[36:39], s70 offen
    buffer_load_dwordx4 v[232:235], v6, s[40:43], s70 offen
    buffer_load_dwordx4 v[236:239], v7, s[40:43], s70 offen
    s_mov_b32 s70, 7168
    buffer_load_dwordx4 v[240:243], v4, s[36:39], s70 offen
    buffer_load_dwordx4 v[244:247], v5, s[36:39], s70 offen
    buffer_load_dwordx4 v[248:251], v6, s[40:43], s70 offen
    buffer_load_dwordx4 v[252:255], v7, s[40:43], s70 offen
    s_waitcnt vmcnt(28)
    v_mfma_f32_32x32x16_bf16 v[64:79], v[128:131], v[136:139], v[64:79]
    v_mfma_f32_32x32x16_bf16 v[80:95], v[128:131], v[140:143], v[80:95]
    v_mfma_f32_32x32x16_bf16 v[96:111], v[132:135], v[136:139], v[96:111]
    v_mfma_f32_32x32x16_bf16 v[112:127], v[132:135], v[140:143], v[112:127]
    s_mov_b32 s70, 8192
    buffer_load_dwordx4 v[128:131], v4, s[36:39], s70 offen
    buffer_load_dwordx4 v[132:135], v5, s[36:39], s70 offen
    buffer_load_dwordx4 v[136:139], v6, s[40:43], s70 offen
    buffer_load_dwordx4 v[140:143], v7, s[40:43], s70 offen
    s_waitcnt vmcnt(28)
    v_mfma_f32_32x32x16_bf16 v[64:79], v[144:147], v[152:155], v[64:79]
    v_mfma_f32_32x32x16_bf16 v[80:95], v[144:147], v[156:159], v[80:95]
    v_mfma_f32_32x32x16_bf16 v[96:111], v[148:151], v[152:155], v[96:111]
    v_mfma_f32_32x32x16_bf16 v[112:127], v[148:151], v[156:159], v[112:127]
    s_mov_b32 s70, 9216
    buffer_load_dwordx4 v[144:147], v4, s[36:39], s70 offen
    buffer_load_dwordx4 v[148:151], v5, s[36:39], s70 offen
    buffer_load_dwordx4 v[152:155], v6, s[40:43], s70 offen
    buffer_load_dwordx4 v[156:159], v7, s[40:43], s70 offen
    s_waitcnt vmcnt(28)
    v_mfma_f32_32x32x16_bf16 v[64:79], v[160:163], v[168:171], v[64:79]
    v_mfma_f32_32x32x16_bf16 v[80:95], v[160:163], v[172:175], v[80:95]
    v_mfma_f32_32x32x16_bf16 v[96:111], v[164:167], v[168:171], v[96:111]
    v_mfma_f32_32x32x16_bf16 v[112:127], v[164:167], v[172:175], v[112:127]
    s_mov_b32 s70, 10240
    buffer_load_dwordx4 v[160:163], v4, s[36:39], s70 offen
    buffer_load_dwordx4 v[164:167], v5, s[36:39], s70 offen
    buffer_load_dwordx4 v[168:171], v6, s[40:43], s70 offen
    buffer_load_dwordx4 v[172:175], v7, s[40:43], s70 offen
    s_waitcnt vmcnt(28)
    v_mfma_f32_32x32x16_bf16 v[64:79], v[176:179], v[184:187], v[64:79]
    v_mfma_f32_32x32x16_bf16 v[80:95], v[176:179], v[188:191], v[80:95]
    v_mfma_f32_32x32x16_bf16 v[96:111], v[180:183], v[184:187], v[96:111]
    v_mfma_f32_32x32x16_bf16 v[112:127], v[180:183], v[188:191], v[112:127]
    s_mov_b32 s70, 11264
    buffer_load_dwordx4 v[176:179], v4, s[36:39], s70 offen
    buffer_load_dwordx4 v[180:183], v5, s[36:39], s70 offen
    buffer_load_dwordx4 v[184:187], v6, s[40:43], s70 offen
    buffer_load_dwordx4 v[188:191], v7, s[40:43], s70 offen
    s_waitcnt vmcnt(28)
    v_mfma_f32_32x32x16_bf16 v[64:79], v[192:195], v[200:203], v[64:79]
    v_mfma_f32_32x32x16_bf16 v[80:95], v[192:195], v[204:207], v[80:95]
    v_mfma_f32_32x32x16_bf16 v[96:111], v[196:199], v[200:203], v[96:111]
    v_mfma_f32_32x32x16_bf16 v[112:127], v[196:199], v[204:207], v[112:127]
    s_mov_b32 s70, 12288
    buffer_load_dwordx4 v[192:195], v4, s[36:39], s70 offen
    buffer_load_dwordx4 v[196:199], v5, s[36:39], s70 offen
    buffer_load_dwordx4 v[200:203], v6, s[40:43], s70 offen
    buffer_load_dwordx4 v[204:207], v7, s[40:43], s70 offen
    s_waitcnt vmcnt(28)
    v_mfma_f32_32x32x16_bf16 v[64:79], v[208:211], v[216:219], v[64:79]
    v_mfma_f32_32x32x16_bf16 v[80:95], v[208:211], v[220:223], v[80:95]
    v_mfma_f32_32x32x16_bf16 v[96:111], v[212:215], v[216:219], v[96:111]
    v_mfma_f32_32x32x16_bf16 v[112:127], v[212:215], v[220:223], v[112:127]
    s_mov_b32 s70, 13312
    buffer_load_dwordx4 v[208:211], v4, s[36:39], s70 offen
    buffer_load_dwordx4 v[212:215], v5, s[36:39], s70 offen
    buffer_load_dwordx4 v[216:219], v6, s[40:43], s70 offen
    buffer_load_dwordx4 v[220:223], v7, s[40:43], s70 offen
    s_waitcnt vmcnt(28)
    v_mfma_f32_32x32x16_bf16 v[64:79], v[224:227], v[232:235], v[64:79]
    v_mfma_f32_32x32x16_bf16 v[80:95], v[224:227], v[236:239], v[80:95]
    v_mfma_f32_32x32x16_bf16 v[96:111], v[228:231], v[232:235], v[96:111]
    v_mfma_f32_32x32x16_bf16 v[112:127], v[228:231], v[236:239], v[112:127]
    s_mov_b32 s70, 14336
    buffer_load_dwordx4 v[224:227], v4, s[36:39], s70 offen
    buffer_load_dwordx4 v[228:231], v5, s[36:39], s70 offen
    buffer_load_dwordx4 v[232:235], v6, s[40:43], s70 offen
    buffer_load_dwordx4 v[236:239], v7, s[40:43], s70 offen
    s_waitcnt vmcnt(28)
    v_mfma_f32_32x32x16_bf16 v[64:79], v[240:243], v[248:251], v[64:79]
    v_mfma_f32_32x32x16_bf16 v[80:95], v[240:243], v[252:255], v[80:95]
    v_mfma_f32_32x32x16_bf16 v[96:111], v[244:247], v[248:251], v[96:111]
    v_mfma_f32_32x32x16_bf16 v[112:127], v[244:247], v[252:255], v[112:127]
    s_mov_b32 s70, 15360
    buffer_load_dwordx4 v[240:243], v4, s[36:39], s70 offen
    buffer_load_dwordx4 v[244:247], v5, s[36:39], s70 offen
    buffer_load_dwordx4 v[248:251], v6, s[40:43], s70 offen
    buffer_load_dwordx4 v[252:255], v7, s[40:43], s70 offen
    s_waitcnt vmcnt(28)
    v_mfma_f32_32x32x16_bf16 v[64:79], v[128:131], v[136:139], v[64:79]
    v_mfma_f32_32x32x16_bf16 v[80:95], v[128:131], v[140:143], v[80:95]
    v_mfma_f32_32x32x16_bf16 v[96:111], v[132:135], v[136:139], v[96:111]
    v_mfma_f32_32x32x16_bf16 v[112:127], v[132:135], v[140:143], v[112:127]
    s_mov_b32 s70, 16384
    buffer_load_dwordx4 v[128:131], v4, s[36:39], s70 offen
    buffer_load_dwordx4 v[132:135], v5, s[36:39], s70 offen
    buffer_load_dwordx4 v[136:139], v6, s[40:43], s70 offen
    buffer_load_dwordx4 v[140:143], v7, s[40:43], s70 offen
    s_waitcnt vmcnt(28)
    v_mfma_f32_32x32x16_bf16 v[64:79], v[144:147], v[152:155], v[64:79]
    v_mfma_f32_32x32x16_bf16 v[80:95], v[144:147], v[156:159], v[80:95]
    v_mfma_f32_32x32x16_bf16 v[96:111], v[148:151], v[152:155], v[96:111]
    v_mfma_f32_32x32x16_bf16 v[112:127], v[148:151], v[156:159], v[112:127]
    s_mov_b32 s70, 17408
    buffer_load_dwordx4 v[144:147], v4, s[36:39], s70 offen
    buffer_load_dwordx4 v[148:151], v5, s[36:39], s70 offen
    buffer_load_dwordx4 v[152:155], v6, s[40:43], s70 offen
    buffer_load_dwordx4 v[156:159], v7, s[40:43], s70 offen
    s_waitcnt vmcnt(28)
    v_mfma_f32_32x32x16_bf16 v[64:79], v[160:163], v[168:171], v[64:79]
    v_mfma_f32_32x32x16_bf16 v[80:95], v[160:163], v[172:175], v[80:95]
    v_mfma_f32_32x32x16_bf16 v[96:111], v[164:167], v[168:171], v[96:111]
    v_mfma_f32_32x32x16_bf16 v[112:127], v[164:167], v[172:175], v[112:127]
    s_mov_b32 s70, 18432
    buffer_load_dwordx4 v[160:163], v4, s[36:39], s70 offen
    buffer_load_dwordx4 v[164:167], v5, s[36:39], s70 offen
    buffer_load_dwordx4 v[168:171], v6, s[40:43], s70 offen
    buffer_load_dwordx4 v[172:175], v7, s[40:43], s70 offen
    s_waitcnt vmcnt(28)
    v_mfma_f32_32x32x16_bf16 v[64:79], v[176:179], v[184:187], v[64:79]
    v_mfma_f32_32x32x16_bf16 v[80:95], v[176:179], v[188:191], v[80:95]
    v_mfma_f32_32x32x16_bf16 v[96:111], v[180:183], v[184:187], v[96:111]
    v_mfma_f32_32x32x16_bf16 v[112:127], v[180:183], v[188:191], v[112:127]
    s_mov_b32 s70, 19456
    buffer_load_dwordx4 v[176:179], v4, s[36:39], s70 offen
    buffer_load_dwordx4 v[180:183], v5, s[36:39], s70 offen
    buffer_load_dwordx4 v[184:187], v6, s[40:43], s70 offen
    buffer_load_dwordx4 v[188:191], v7, s[40:43], s70 offen
    s_waitcnt vmcnt(28)
    v_mfma_f32_32x32x16_bf16 v[64:79], v[192:195], v[200:203], v[64:79]
    v_mfma_f32_32x32x16_bf16 v[80:95], v[192:195], v[204:207], v[80:95]
    v_mfma_f32_32x32x16_bf16 v[96:111], v[196:199], v[200:203], v[96:111]
    v_mfma_f32_32x32x16_bf16 v[112:127], v[196:199], v[204:207], v[112:127]
    s_mov_b32 s70, 20480
    buffer_load_dwordx4 v[192:195], v4, s[36:39], s70 offen
    buffer_load_dwordx4 v[196:199], v5, s[36:39], s70 offen
    buffer_load_dwordx4 v[200:203], v6, s[40:43], s70 offen
    buffer_load_dwordx4 v[204:207], v7, s[40:43], s70 offen
    s_waitcnt vmcnt(28)
    v_mfma_f32_32x32x16_bf16 v[64:79], v[208:211], v[216:219], v[64:79]
    v_mfma_f32_32x32x16_bf16 v[80:95], v[208:211], v[220:223], v[80:95]
    v_mfma_f32_32x32x16_bf16 v[96:111], v[212:215], v[216:219], v[96:111]
    v_mfma_f32_32x32x16_bf16 v[112:127], v[212:215], v[220:223], v[112:127]
    s_mov_b32 s70, 21504
    buffer_load_dwordx4 v[208:211], v4, s[36:39], s70 offen
    buffer_load_dwordx4 v[212:215], v5, s[36:39], s70 offen
    buffer_load_dwordx4 v[216:219], v6, s[40:43], s70 offen
    buffer_load_dwordx4 v[220:223], v7, s[40:43], s70 offen
    s_waitcnt vmcnt(28)
    v_mfma_f32_32x32x16_bf16 v[64:79], v[224:227], v[232:235], v[64:79]
    v_mfma_f32_32x32x16_bf16 v[80:95], v[224:227], v[236:239], v[80:95]
    v_mfma_f32_32x32x16_bf16 v[96:111], v[228:231], v[232:235], v[96:111]
    v_mfma_f32_32x32x16_bf16 v[112:127], v[228:231], v[236:239], v[112:127]
    s_mov_b32 s70, 22528
    buffer_load_dwordx4 v[224:227], v4, s[36:39], s70 offen
    buffer_load_dwordx4 v[228:231], v5, s[36:39], s70 offen
    buffer_load_dwordx4 v[232:235], v6, s[40:43], s70 offen
    buffer_load_dwordx4 v[236:239], v7, s[40:43], s70 offen
    s_waitcnt vmcnt(28)
    v_mfma_f32_32x32x16_bf16 v[64:79], v[240:243], v[248:251], v[64:79]
    v_mfma_f32_32x32x16_bf16 v[80:95], v[240:243], v[252:255], v[80:95]
    v_mfma_f32_32x32x16_bf16 v[96:111], v[244:247], v[248:251], v[96:111]
    v_mfma_f32_32x32x16_bf16 v[112:127], v[244:247], v[252:255], v[112:127]
    s_mov_b32 s70, 23552
    buffer_load_dwordx4 v[240:243], v4, s[36:39], s70 offen
    buffer_load_dwordx4 v[244:247], v5, s[36:39], s70 offen
    buffer_load_dwordx4 v[248:251], v6, s[40:43], s70 offen
    buffer_load_dwordx4 v[252:255], v7, s[40:43], s70 offen
    s_waitcnt vmcnt(28)
    v_mfma_f32_32x32x16_bf16 v[64:79], v[128:131], v[136:139], v[64:79]
    v_mfma_f32_32x32x16_bf16 v[80:95], v[128:131], v[140:143], v[80:95]
    v_mfma_f32_32x32x16_bf16 v[96:111], v[132:135], v[136:139], v[96:111]
    v_mfma_f32_32x32x16_bf16 v[112:127], v[132:135], v[140:143], v[112:127]
    s_mov_b32 s70, 24576
    buffer_load_dwordx4 v[128:131], v4, s[36:39], s70 offen
    buffer_load_dwordx4 v[132:135], v5, s[36:39], s70 offen
    buffer_load_dwordx4 v[136:139], v6, s[40:43], s70 offen
    buffer_load_dwordx4 v[140:143], v7, s[40:43], s70 offen
    s_waitcnt vmcnt(28)
    v_mfma_f32_32x32x16_bf16 v[64:79], v[144:147], v[152:155], v[64:79]
    v_mfma_f32_32x32x16_bf16 v[80:95], v[144:147], v[156:159], v[80:95]
    v_mfma_f32_32x32x16_bf16 v[96:111], v[148:151], v[152:155], v[96:111]
    v_mfma_f32_32x32x16_bf16 v[112:127], v[148:151], v[156:159], v[112:127]
    s_mov_b32 s70, 25600
    buffer_load_dwordx4 v[144:147], v4, s[36:39], s70 offen
    buffer_load_dwordx4 v[148:151], v5, s[36:39], s70 offen
    buffer_load_dwordx4 v[152:155], v6, s[40:43], s70 offen
    buffer_load_dwordx4 v[156:159], v7, s[40:43], s70 offen
    s_waitcnt vmcnt(28)
    v_mfma_f32_32x32x16_bf16 v[64:79], v[160:163], v[168:171], v[64:79]
    v_mfma_f32_32x32x16_bf16 v[80:95], v[160:163], v[172:175], v[80:95]
    v_mfma_f32_32x32x16_bf16 v[96:111], v[164:167], v[168:171], v[96:111]
    v_mfma_f32_32x32x16_bf16 v[112:127], v[164:167], v[172:175], v[112:127]
    s_mov_b32 s70, 26624
    buffer_load_dwordx4 v[160:163], v4, s[36:39], s70 offen
    buffer_load_dwordx4 v[164:167], v5, s[36:39], s70 offen
    buffer_load_dwordx4 v[168:171], v6, s[40:43], s70 offen
    buffer_load_dwordx4 v[172:175], v7, s[40:43], s70 offen
    s_waitcnt vmcnt(28)
    v_mfma_f32_32x32x16_bf16 v[64:79], v[176:179], v[184:187], v[64:79]
    v_mfma_f32_32x32x16_bf16 v[80:95], v[176:179], v[188:191], v[80:95]
    v_mfma_f32_32x32x16_bf16 v[96:111], v[180:183], v[184:187], v[96:111]
    v_mfma_f32_32x32x16_bf16 v[112:127], v[180:183], v[188:191], v[112:127]
    s_mov_b32 s70, 27648
    buffer_load_dwordx4 v[176:179], v4, s[36:39], s70 offen
    buffer_load_dwordx4 v[180:183], v5, s[36:39], s70 offen
    buffer_load_dwordx4 v[184:187], v6, s[40:43], s70 offen
    buffer_load_dwordx4 v[188:191], v7, s[40:43], s70 offen
    s_waitcnt vmcnt(28)
    v_mfma_f32_32x32x16_bf16 v[64:79], v[192:195], v[200:203], v[64:79]
    v_mfma_f32_32x32x16_bf16 v[80:95], v[192:195], v[204:207], v[80:95]
    v_mfma_f32_32x32x16_bf16 v[96:111], v[196:199], v[200:203], v[96:111]
    v_mfma_f32_32x32x16_bf16 v[112:127], v[196:199], v[204:207], v[112:127]
    s_waitcnt vmcnt(24)
    v_mfma_f32_32x32x16_bf16 v[64:79], v[208:211], v[216:219], v[64:79]
    v_mfma_f32_32x32x16_bf16 v[80:95], v[208:211], v[220:223], v[80:95]
    v_mfma_f32_32x32x16_bf16 v[96:111], v[212:215], v[216:219], v[96:111]
    v_mfma_f32_32x32x16_bf16 v[112:127], v[212:215], v[220:223], v[112:127]
    s_waitcnt vmcnt(20)
    v_mfma_f32_32x32x16_bf16 v[64:79], v[224:227], v[232:235], v[64:79]
    v_mfma_f32_32x32x16_bf16 v[80:95], v[224:227], v[236:239], v[80:95]
    v_mfma_f32_32x32x16_bf16 v[96:111], v[228:231], v[232:235], v[96:111]
    v_mfma_f32_32x32x16_bf16 v[112:127], v[228:231], v[236:239], v[112:127]
    s_waitcnt vmcnt(16)
    v_mfma_f32_32x32x16_bf16 v[64:79], v[240:243], v[248:251], v[64:79]
    v_mfma_f32_32x32x16_bf16 v[80:95], v[240:243], v[252:255], v[80:95]
    v_mfma_f32_32x32x16_bf16 v[96:111], v[244:247], v[248:251], v[96:111]
    v_mfma_f32_32x32x16_bf16 v[112:127], v[244:247], v[252:255], v[112:127]
    s_waitcnt vmcnt(12)
    v_mfma_f32_32x32x16_bf16 v[64:79], v[128:131], v[136:139], v[64:79]
    v_mfma_f32_32x32x16_bf16 v[80:95], v[128:131], v[140:143], v[80:95]
    v_mfma_f32_32x32x16_bf16 v[96:111], v[132:135], v[136:139], v[96:111]
    v_mfma_f32_32x32x16_bf16 v[112:127], v[132:135], v[140:143], v[112:127]
    s_waitcnt vmcnt(8)
    v_mfma_f32_32x32x16_bf16 v[64:79], v[144:147], v[152:155], v[64:79]
    v_mfma_f32_32x32x16_bf16 v[80:95], v[144:147], v[156:159], v[80:95]
    v_mfma_f32_32x32x16_bf16 v[96:111], v[148:151], v[152:155], v[96:111]
    v_mfma_f32_32x32x16_bf16 v[112:127], v[148:151], v[156:159], v[112:127]
    s_waitcnt vmcnt(4)
    v_mfma_f32_32x32x16_bf16 v[64:79], v[160:163], v[168:171], v[64:79]
    v_mfma_f32_32x32x16_bf16 v[80:95], v[160:163], v[172:175], v[80:95]
    v_mfma_f32_32x32x16_bf16 v[96:111], v[164:167], v[168:171], v[96:111]
    v_mfma_f32_32x32x16_bf16 v[112:127], v[164:167], v[172:175], v[112:127]
    s_waitcnt vmcnt(0)
    v_mfma_f32_32x32x16_bf16 v[64:79], v[176:179], v[184:187], v[64:79]
    v_mfma_f32_32x32x16_bf16 v[80:95], v[176:179], v[188:191], v[80:95]
    v_mfma_f32_32x32x16_bf16 v[96:111], v[180:183], v[184:187], v[96:111]
    v_mfma_f32_32x32x16_bf16 v[112:127], v[180:183], v[188:191], v[112:127]
    s_nop 15
    v_lshrrev_b32 v8, 5, v1
    v_lshlrev_b32 v8, 3, v8
    s_lshl_b32 s68, s66, 6
    buffer_load_dwordx2 v[128:129], v8, s[48:51], s68 offen offset:0
    buffer_load_dwordx2 v[130:131], v8, s[48:51], s68 offen offset:16
    buffer_load_dwordx2 v[132:133], v8, s[48:51], s68 offen offset:32
    buffer_load_dwordx2 v[134:135], v8, s[48:51], s68 offen offset:48
    buffer_load_dwordx2 v[136:137], v8, s[48:51], s68 offen offset:64
    buffer_load_dwordx2 v[138:139], v8, s[48:51], s68 offen offset:80
    buffer_load_dwordx2 v[140:141], v8, s[48:51], s68 offen offset:96
    buffer_load_dwordx2 v[142:143], v8, s[48:51], s68 offen offset:112
    s_waitcnt vmcnt(0)
    v_lshlrev_b32 v10, 16, v128
    v_and_b32 v11, 0xffff0000, v128
    v_lshlrev_b32 v12, 16, v129
    v_and_b32 v13, 0xffff0000, v129
    v_cvt_pk_bf16_f32 v64, v64, v64
    v_lshlrev_b32 v64, 16, v64
    v_add_f32 v64, v64, v10
    v_cvt_pk_bf16_f32 v64, v64, v64
    v_lshlrev_b32 v64, 16, v64
    v_max_f32 v64, 0, v64
    v_mul_f32 v64, v64, v64
    v_cvt_pk_bf16_f32 v65, v65, v65
    v_lshlrev_b32 v65, 16, v65
    v_add_f32 v65, v65, v11
    v_cvt_pk_bf16_f32 v65, v65, v65
    v_lshlrev_b32 v65, 16, v65
    v_max_f32 v65, 0, v65
    v_mul_f32 v65, v65, v65
    v_cvt_pk_bf16_f32 v66, v66, v66
    v_lshlrev_b32 v66, 16, v66
    v_add_f32 v66, v66, v12
    v_cvt_pk_bf16_f32 v66, v66, v66
    v_lshlrev_b32 v66, 16, v66
    v_max_f32 v66, 0, v66
    v_mul_f32 v66, v66, v66
    v_cvt_pk_bf16_f32 v67, v67, v67
    v_lshlrev_b32 v67, 16, v67
    v_add_f32 v67, v67, v13
    v_cvt_pk_bf16_f32 v67, v67, v67
    v_lshlrev_b32 v67, 16, v67
    v_max_f32 v67, 0, v67
    v_mul_f32 v67, v67, v67
    v_cvt_pk_bf16_f32 v16, v64, v65
    v_cvt_pk_bf16_f32 v17, v66, v67
    v_lshlrev_b32 v10, 16, v130
    v_and_b32 v11, 0xffff0000, v130
    v_lshlrev_b32 v12, 16, v131
    v_and_b32 v13, 0xffff0000, v131
    v_cvt_pk_bf16_f32 v68, v68, v68
    v_lshlrev_b32 v68, 16, v68
    v_add_f32 v68, v68, v10
    v_cvt_pk_bf16_f32 v68, v68, v68
    v_lshlrev_b32 v68, 16, v68
    v_max_f32 v68, 0, v68
    v_mul_f32 v68, v68, v68
    v_cvt_pk_bf16_f32 v69, v69, v69
    v_lshlrev_b32 v69, 16, v69
    v_add_f32 v69, v69, v11
    v_cvt_pk_bf16_f32 v69, v69, v69
    v_lshlrev_b32 v69, 16, v69
    v_max_f32 v69, 0, v69
    v_mul_f32 v69, v69, v69
    v_cvt_pk_bf16_f32 v70, v70, v70
    v_lshlrev_b32 v70, 16, v70
    v_add_f32 v70, v70, v12
    v_cvt_pk_bf16_f32 v70, v70, v70
    v_lshlrev_b32 v70, 16, v70
    v_max_f32 v70, 0, v70
    v_mul_f32 v70, v70, v70
    v_cvt_pk_bf16_f32 v71, v71, v71
    v_lshlrev_b32 v71, 16, v71
    v_add_f32 v71, v71, v13
    v_cvt_pk_bf16_f32 v71, v71, v71
    v_lshlrev_b32 v71, 16, v71
    v_max_f32 v71, 0, v71
    v_mul_f32 v71, v71, v71
    v_cvt_pk_bf16_f32 v18, v68, v69
    v_cvt_pk_bf16_f32 v19, v70, v71
    v_lshlrev_b32 v10, 16, v132
    v_and_b32 v11, 0xffff0000, v132
    v_lshlrev_b32 v12, 16, v133
    v_and_b32 v13, 0xffff0000, v133
    v_cvt_pk_bf16_f32 v72, v72, v72
    v_lshlrev_b32 v72, 16, v72
    v_add_f32 v72, v72, v10
    v_cvt_pk_bf16_f32 v72, v72, v72
    v_lshlrev_b32 v72, 16, v72
    v_max_f32 v72, 0, v72
    v_mul_f32 v72, v72, v72
    v_cvt_pk_bf16_f32 v73, v73, v73
    v_lshlrev_b32 v73, 16, v73
    v_add_f32 v73, v73, v11
    v_cvt_pk_bf16_f32 v73, v73, v73
    v_lshlrev_b32 v73, 16, v73
    v_max_f32 v73, 0, v73
    v_mul_f32 v73, v73, v73
    v_cvt_pk_bf16_f32 v74, v74, v74
    v_lshlrev_b32 v74, 16, v74
    v_add_f32 v74, v74, v12
    v_cvt_pk_bf16_f32 v74, v74, v74
    v_lshlrev_b32 v74, 16, v74
    v_max_f32 v74, 0, v74
    v_mul_f32 v74, v74, v74
    v_cvt_pk_bf16_f32 v75, v75, v75
    v_lshlrev_b32 v75, 16, v75
    v_add_f32 v75, v75, v13
    v_cvt_pk_bf16_f32 v75, v75, v75
    v_lshlrev_b32 v75, 16, v75
    v_max_f32 v75, 0, v75
    v_mul_f32 v75, v75, v75
    v_cvt_pk_bf16_f32 v20, v72, v73
    v_cvt_pk_bf16_f32 v21, v74, v75
    v_lshlrev_b32 v10, 16, v134
    v_and_b32 v11, 0xffff0000, v134
    v_lshlrev_b32 v12, 16, v135
    v_and_b32 v13, 0xffff0000, v135
    v_cvt_pk_bf16_f32 v76, v76, v76
    v_lshlrev_b32 v76, 16, v76
    v_add_f32 v76, v76, v10
    v_cvt_pk_bf16_f32 v76, v76, v76
    v_lshlrev_b32 v76, 16, v76
    v_max_f32 v76, 0, v76
    v_mul_f32 v76, v76, v76
    v_cvt_pk_bf16_f32 v77, v77, v77
    v_lshlrev_b32 v77, 16, v77
    v_add_f32 v77, v77, v11
    v_cvt_pk_bf16_f32 v77, v77, v77
    v_lshlrev_b32 v77, 16, v77
    v_max_f32 v77, 0, v77
    v_mul_f32 v77, v77, v77
    v_cvt_pk_bf16_f32 v78, v78, v78
    v_lshlrev_b32 v78, 16, v78
    v_add_f32 v78, v78, v12
    v_cvt_pk_bf16_f32 v78, v78, v78
    v_lshlrev_b32 v78, 16, v78
    v_max_f32 v78, 0, v78
    v_mul_f32 v78, v78, v78
    v_cvt_pk_bf16_f32 v79, v79, v79
    v_lshlrev_b32 v79, 16, v79
    v_add_f32 v79, v79, v13
    v_cvt_pk_bf16_f32 v79, v79, v79
    v_lshlrev_b32 v79, 16, v79
    v_max_f32 v79, 0, v79
    v_mul_f32 v79, v79, v79
    v_cvt_pk_bf16_f32 v22, v76, v77
    v_cvt_pk_bf16_f32 v23, v78, v79
    s_nop 1
    v_permlane32_swap_b32 v16, v18
    v_permlane32_swap_b32 v17, v19
    v_permlane32_swap_b32 v20, v22
    v_permlane32_swap_b32 v21, v23
    s_add_u32 s69, s67, 0
    s_mul_i32 s69, s69, 112
    s_lshl_b32 s70, s66, 1
    s_add_u32 s69, s69, s70
    s_add_u32 s69, s69, 0
    s_lshl_b32 s69, s69, 10
    buffer_store_dwordx4 v[16:19], v3, s[44:47], s69 offen
    buffer_store_dwordx4 v[20:23], v3, s[44:47], s69 offen offset:1024
    s_nop 1
    v_lshlrev_b32 v10, 16, v128
    v_and_b32 v11, 0xffff0000, v128
    v_lshlrev_b32 v12, 16, v129
    v_and_b32 v13, 0xffff0000, v129
    v_cvt_pk_bf16_f32 v80, v80, v80
    v_lshlrev_b32 v80, 16, v80
    v_add_f32 v80, v80, v10
    v_cvt_pk_bf16_f32 v80, v80, v80
    v_lshlrev_b32 v80, 16, v80
    v_max_f32 v80, 0, v80
    v_mul_f32 v80, v80, v80
    v_cvt_pk_bf16_f32 v81, v81, v81
    v_lshlrev_b32 v81, 16, v81
    v_add_f32 v81, v81, v11
    v_cvt_pk_bf16_f32 v81, v81, v81
    v_lshlrev_b32 v81, 16, v81
    v_max_f32 v81, 0, v81
    v_mul_f32 v81, v81, v81
    v_cvt_pk_bf16_f32 v82, v82, v82
    v_lshlrev_b32 v82, 16, v82
    v_add_f32 v82, v82, v12
    v_cvt_pk_bf16_f32 v82, v82, v82
    v_lshlrev_b32 v82, 16, v82
    v_max_f32 v82, 0, v82
    v_mul_f32 v82, v82, v82
    v_cvt_pk_bf16_f32 v83, v83, v83
    v_lshlrev_b32 v83, 16, v83
    v_add_f32 v83, v83, v13
    v_cvt_pk_bf16_f32 v83, v83, v83
    v_lshlrev_b32 v83, 16, v83
    v_max_f32 v83, 0, v83
    v_mul_f32 v83, v83, v83
    v_cvt_pk_bf16_f32 v16, v80, v81
    v_cvt_pk_bf16_f32 v17, v82, v83
    v_lshlrev_b32 v10, 16, v130
    v_and_b32 v11, 0xffff0000, v130
    v_lshlrev_b32 v12, 16, v131
    v_and_b32 v13, 0xffff0000, v131
    v_cvt_pk_bf16_f32 v84, v84, v84
    v_lshlrev_b32 v84, 16, v84
    v_add_f32 v84, v84, v10
    v_cvt_pk_bf16_f32 v84, v84, v84
    v_lshlrev_b32 v84, 16, v84
    v_max_f32 v84, 0, v84
    v_mul_f32 v84, v84, v84
    v_cvt_pk_bf16_f32 v85, v85, v85
    v_lshlrev_b32 v85, 16, v85
    v_add_f32 v85, v85, v11
    v_cvt_pk_bf16_f32 v85, v85, v85
    v_lshlrev_b32 v85, 16, v85
    v_max_f32 v85, 0, v85
    v_mul_f32 v85, v85, v85
    v_cvt_pk_bf16_f32 v86, v86, v86
    v_lshlrev_b32 v86, 16, v86
    v_add_f32 v86, v86, v12
    v_cvt_pk_bf16_f32 v86, v86, v86
    v_lshlrev_b32 v86, 16, v86
    v_max_f32 v86, 0, v86
    v_mul_f32 v86, v86, v86
    v_cvt_pk_bf16_f32 v87, v87, v87
    v_lshlrev_b32 v87, 16, v87
    v_add_f32 v87, v87, v13
    v_cvt_pk_bf16_f32 v87, v87, v87
    v_lshlrev_b32 v87, 16, v87
    v_max_f32 v87, 0, v87
    v_mul_f32 v87, v87, v87
    v_cvt_pk_bf16_f32 v18, v84, v85
    v_cvt_pk_bf16_f32 v19, v86, v87
    v_lshlrev_b32 v10, 16, v132
    v_and_b32 v11, 0xffff0000, v132
    v_lshlrev_b32 v12, 16, v133
    v_and_b32 v13, 0xffff0000, v133
    v_cvt_pk_bf16_f32 v88, v88, v88
    v_lshlrev_b32 v88, 16, v88
    v_add_f32 v88, v88, v10
    v_cvt_pk_bf16_f32 v88, v88, v88
    v_lshlrev_b32 v88, 16, v88
    v_max_f32 v88, 0, v88
    v_mul_f32 v88, v88, v88
    v_cvt_pk_bf16_f32 v89, v89, v89
    v_lshlrev_b32 v89, 16, v89
    v_add_f32 v89, v89, v11
    v_cvt_pk_bf16_f32 v89, v89, v89
    v_lshlrev_b32 v89, 16, v89
    v_max_f32 v89, 0, v89
    v_mul_f32 v89, v89, v89
    v_cvt_pk_bf16_f32 v90, v90, v90
    v_lshlrev_b32 v90, 16, v90
    v_add_f32 v90, v90, v12
    v_cvt_pk_bf16_f32 v90, v90, v90
    v_lshlrev_b32 v90, 16, v90
    v_max_f32 v90, 0, v90
    v_mul_f32 v90, v90, v90
    v_cvt_pk_bf16_f32 v91, v91, v91
    v_lshlrev_b32 v91, 16, v91
    v_add_f32 v91, v91, v13
    v_cvt_pk_bf16_f32 v91, v91, v91
    v_lshlrev_b32 v91, 16, v91
    v_max_f32 v91, 0, v91
    v_mul_f32 v91, v91, v91
    v_cvt_pk_bf16_f32 v20, v88, v89
    v_cvt_pk_bf16_f32 v21, v90, v91
    v_lshlrev_b32 v10, 16, v134
    v_and_b32 v11, 0xffff0000, v134
    v_lshlrev_b32 v12, 16, v135
    v_and_b32 v13, 0xffff0000, v135
    v_cvt_pk_bf16_f32 v92, v92, v92
    v_lshlrev_b32 v92, 16, v92
    v_add_f32 v92, v92, v10
    v_cvt_pk_bf16_f32 v92, v92, v92
    v_lshlrev_b32 v92, 16, v92
    v_max_f32 v92, 0, v92
    v_mul_f32 v92, v92, v92
    v_cvt_pk_bf16_f32 v93, v93, v93
    v_lshlrev_b32 v93, 16, v93
    v_add_f32 v93, v93, v11
    v_cvt_pk_bf16_f32 v93, v93, v93
    v_lshlrev_b32 v93, 16, v93
    v_max_f32 v93, 0, v93
    v_mul_f32 v93, v93, v93
    v_cvt_pk_bf16_f32 v94, v94, v94
    v_lshlrev_b32 v94, 16, v94
    v_add_f32 v94, v94, v12
    v_cvt_pk_bf16_f32 v94, v94, v94
    v_lshlrev_b32 v94, 16, v94
    v_max_f32 v94, 0, v94
    v_mul_f32 v94, v94, v94
    v_cvt_pk_bf16_f32 v95, v95, v95
    v_lshlrev_b32 v95, 16, v95
    v_add_f32 v95, v95, v13
    v_cvt_pk_bf16_f32 v95, v95, v95
    v_lshlrev_b32 v95, 16, v95
    v_max_f32 v95, 0, v95
    v_mul_f32 v95, v95, v95
    v_cvt_pk_bf16_f32 v22, v92, v93
    v_cvt_pk_bf16_f32 v23, v94, v95
    s_nop 1
    v_permlane32_swap_b32 v16, v18
    v_permlane32_swap_b32 v17, v19
    v_permlane32_swap_b32 v20, v22
    v_permlane32_swap_b32 v21, v23
    s_add_u32 s69, s67, 1
    s_mul_i32 s69, s69, 112
    s_lshl_b32 s70, s66, 1
    s_add_u32 s69, s69, s70
    s_add_u32 s69, s69, 0
    s_lshl_b32 s69, s69, 10
    buffer_store_dwordx4 v[16:19], v3, s[44:47], s69 offen
    buffer_store_dwordx4 v[20:23], v3, s[44:47], s69 offen offset:1024
    s_nop 1
    v_lshlrev_b32 v10, 16, v136
    v_and_b32 v11, 0xffff0000, v136
    v_lshlrev_b32 v12, 16, v137
    v_and_b32 v13, 0xffff0000, v137
    v_cvt_pk_bf16_f32 v96, v96, v96
    v_lshlrev_b32 v96, 16, v96
    v_add_f32 v96, v96, v10
    v_cvt_pk_bf16_f32 v96, v96, v96
    v_lshlrev_b32 v96, 16, v96
    v_max_f32 v96, 0, v96
    v_mul_f32 v96, v96, v96
    v_cvt_pk_bf16_f32 v97, v97, v97
    v_lshlrev_b32 v97, 16, v97
    v_add_f32 v97, v97, v11
    v_cvt_pk_bf16_f32 v97, v97, v97
    v_lshlrev_b32 v97, 16, v97
    v_max_f32 v97, 0, v97
    v_mul_f32 v97, v97, v97
    v_cvt_pk_bf16_f32 v98, v98, v98
    v_lshlrev_b32 v98, 16, v98
    v_add_f32 v98, v98, v12
    v_cvt_pk_bf16_f32 v98, v98, v98
    v_lshlrev_b32 v98, 16, v98
    v_max_f32 v98, 0, v98
    v_mul_f32 v98, v98, v98
    v_cvt_pk_bf16_f32 v99, v99, v99
    v_lshlrev_b32 v99, 16, v99
    v_add_f32 v99, v99, v13
    v_cvt_pk_bf16_f32 v99, v99, v99
    v_lshlrev_b32 v99, 16, v99
    v_max_f32 v99, 0, v99
    v_mul_f32 v99, v99, v99
    v_cvt_pk_bf16_f32 v16, v96, v97
    v_cvt_pk_bf16_f32 v17, v98, v99
    v_lshlrev_b32 v10, 16, v138
    v_and_b32 v11, 0xffff0000, v138
    v_lshlrev_b32 v12, 16, v139
    v_and_b32 v13, 0xffff0000, v139
    v_cvt_pk_bf16_f32 v100, v100, v100
    v_lshlrev_b32 v100, 16, v100
    v_add_f32 v100, v100, v10
    v_cvt_pk_bf16_f32 v100, v100, v100
    v_lshlrev_b32 v100, 16, v100
    v_max_f32 v100, 0, v100
    v_mul_f32 v100, v100, v100
    v_cvt_pk_bf16_f32 v101, v101, v101
    v_lshlrev_b32 v101, 16, v101
    v_add_f32 v101, v101, v11
    v_cvt_pk_bf16_f32 v101, v101, v101
    v_lshlrev_b32 v101, 16, v101
    v_max_f32 v101, 0, v101
    v_mul_f32 v101, v101, v101
    v_cvt_pk_bf16_f32 v102, v102, v102
    v_lshlrev_b32 v102, 16, v102
    v_add_f32 v102, v102, v12
    v_cvt_pk_bf16_f32 v102, v102, v102
    v_lshlrev_b32 v102, 16, v102
    v_max_f32 v102, 0, v102
    v_mul_f32 v102, v102, v102
    v_cvt_pk_bf16_f32 v103, v103, v103
    v_lshlrev_b32 v103, 16, v103
    v_add_f32 v103, v103, v13
    v_cvt_pk_bf16_f32 v103, v103, v103
    v_lshlrev_b32 v103, 16, v103
    v_max_f32 v103, 0, v103
    v_mul_f32 v103, v103, v103
    v_cvt_pk_bf16_f32 v18, v100, v101
    v_cvt_pk_bf16_f32 v19, v102, v103
    v_lshlrev_b32 v10, 16, v140
    v_and_b32 v11, 0xffff0000, v140
    v_lshlrev_b32 v12, 16, v141
    v_and_b32 v13, 0xffff0000, v141
    v_cvt_pk_bf16_f32 v104, v104, v104
    v_lshlrev_b32 v104, 16, v104
    v_add_f32 v104, v104, v10
    v_cvt_pk_bf16_f32 v104, v104, v104
    v_lshlrev_b32 v104, 16, v104
    v_max_f32 v104, 0, v104
    v_mul_f32 v104, v104, v104
    v_cvt_pk_bf16_f32 v105, v105, v105
    v_lshlrev_b32 v105, 16, v105
    v_add_f32 v105, v105, v11
    v_cvt_pk_bf16_f32 v105, v105, v105
    v_lshlrev_b32 v105, 16, v105
    v_max_f32 v105, 0, v105
    v_mul_f32 v105, v105, v105
    v_cvt_pk_bf16_f32 v106, v106, v106
    v_lshlrev_b32 v106, 16, v106
    v_add_f32 v106, v106, v12
    v_cvt_pk_bf16_f32 v106, v106, v106
    v_lshlrev_b32 v106, 16, v106
    v_max_f32 v106, 0, v106
    v_mul_f32 v106, v106, v106
    v_cvt_pk_bf16_f32 v107, v107, v107
    v_lshlrev_b32 v107, 16, v107
    v_add_f32 v107, v107, v13
    v_cvt_pk_bf16_f32 v107, v107, v107
    v_lshlrev_b32 v107, 16, v107
    v_max_f32 v107, 0, v107
    v_mul_f32 v107, v107, v107
    v_cvt_pk_bf16_f32 v20, v104, v105
    v_cvt_pk_bf16_f32 v21, v106, v107
    v_lshlrev_b32 v10, 16, v142
    v_and_b32 v11, 0xffff0000, v142
    v_lshlrev_b32 v12, 16, v143
    v_and_b32 v13, 0xffff0000, v143
    v_cvt_pk_bf16_f32 v108, v108, v108
    v_lshlrev_b32 v108, 16, v108
    v_add_f32 v108, v108, v10
    v_cvt_pk_bf16_f32 v108, v108, v108
    v_lshlrev_b32 v108, 16, v108
    v_max_f32 v108, 0, v108
    v_mul_f32 v108, v108, v108
    v_cvt_pk_bf16_f32 v109, v109, v109
    v_lshlrev_b32 v109, 16, v109
    v_add_f32 v109, v109, v11
    v_cvt_pk_bf16_f32 v109, v109, v109
    v_lshlrev_b32 v109, 16, v109
    v_max_f32 v109, 0, v109
    v_mul_f32 v109, v109, v109
    v_cvt_pk_bf16_f32 v110, v110, v110
    v_lshlrev_b32 v110, 16, v110
    v_add_f32 v110, v110, v12
    v_cvt_pk_bf16_f32 v110, v110, v110
    v_lshlrev_b32 v110, 16, v110
    v_max_f32 v110, 0, v110
    v_mul_f32 v110, v110, v110
    v_cvt_pk_bf16_f32 v111, v111, v111
    v_lshlrev_b32 v111, 16, v111
    v_add_f32 v111, v111, v13
    v_cvt_pk_bf16_f32 v111, v111, v111
    v_lshlrev_b32 v111, 16, v111
    v_max_f32 v111, 0, v111
    v_mul_f32 v111, v111, v111
    v_cvt_pk_bf16_f32 v22, v108, v109
    v_cvt_pk_bf16_f32 v23, v110, v111
    s_nop 1
    v_permlane32_swap_b32 v16, v18
    v_permlane32_swap_b32 v17, v19
    v_permlane32_swap_b32 v20, v22
    v_permlane32_swap_b32 v21, v23
    s_add_u32 s69, s67, 0
    s_mul_i32 s69, s69, 112
    s_lshl_b32 s70, s66, 1
    s_add_u32 s69, s69, s70
    s_add_u32 s69, s69, 2
    s_lshl_b32 s69, s69, 10
    buffer_store_dwordx4 v[16:19], v3, s[44:47], s69 offen
    buffer_store_dwordx4 v[20:23], v3, s[44:47], s69 offen offset:1024
    s_nop 1
    v_lshlrev_b32 v10, 16, v136
    v_and_b32 v11, 0xffff0000, v136
    v_lshlrev_b32 v12, 16, v137
    v_and_b32 v13, 0xffff0000, v137
    v_cvt_pk_bf16_f32 v112, v112, v112
    v_lshlrev_b32 v112, 16, v112
    v_add_f32 v112, v112, v10
    v_cvt_pk_bf16_f32 v112, v112, v112
    v_lshlrev_b32 v112, 16, v112
    v_max_f32 v112, 0, v112
    v_mul_f32 v112, v112, v112
    v_cvt_pk_bf16_f32 v113, v113, v113
    v_lshlrev_b32 v113, 16, v113
    v_add_f32 v113, v113, v11
    v_cvt_pk_bf16_f32 v113, v113, v113
    v_lshlrev_b32 v113, 16, v113
    v_max_f32 v113, 0, v113
    v_mul_f32 v113, v113, v113
    v_cvt_pk_bf16_f32 v114, v114, v114
    v_lshlrev_b32 v114, 16, v114
    v_add_f32 v114, v114, v12
    v_cvt_pk_bf16_f32 v114, v114, v114
    v_lshlrev_b32 v114, 16, v114
    v_max_f32 v114, 0, v114
    v_mul_f32 v114, v114, v114
    v_cvt_pk_bf16_f32 v115, v115, v115
    v_lshlrev_b32 v115, 16, v115
    v_add_f32 v115, v115, v13
    v_cvt_pk_bf16_f32 v115, v115, v115
    v_lshlrev_b32 v115, 16, v115
    v_max_f32 v115, 0, v115
    v_mul_f32 v115, v115, v115
    v_cvt_pk_bf16_f32 v16, v112, v113
    v_cvt_pk_bf16_f32 v17, v114, v115
    v_lshlrev_b32 v10, 16, v138
    v_and_b32 v11, 0xffff0000, v138
    v_lshlrev_b32 v12, 16, v139
    v_and_b32 v13, 0xffff0000, v139
    v_cvt_pk_bf16_f32 v116, v116, v116
    v_lshlrev_b32 v116, 16, v116
    v_add_f32 v116, v116, v10
    v_cvt_pk_bf16_f32 v116, v116, v116
    v_lshlrev_b32 v116, 16, v116
    v_max_f32 v116, 0, v116
    v_mul_f32 v116, v116, v116
    v_cvt_pk_bf16_f32 v117, v117, v117
    v_lshlrev_b32 v117, 16, v117
    v_add_f32 v117, v117, v11
    v_cvt_pk_bf16_f32 v117, v117, v117
    v_lshlrev_b32 v117, 16, v117
    v_max_f32 v117, 0, v117
    v_mul_f32 v117, v117, v117
    v_cvt_pk_bf16_f32 v118, v118, v118
    v_lshlrev_b32 v118, 16, v118
    v_add_f32 v118, v118, v12
    v_cvt_pk_bf16_f32 v118, v118, v118
    v_lshlrev_b32 v118, 16, v118
    v_max_f32 v118, 0, v118
    v_mul_f32 v118, v118, v118
    v_cvt_pk_bf16_f32 v119, v119, v119
    v_lshlrev_b32 v119, 16, v119
    v_add_f32 v119, v119, v13
    v_cvt_pk_bf16_f32 v119, v119, v119
    v_lshlrev_b32 v119, 16, v119
    v_max_f32 v119, 0, v119
    v_mul_f32 v119, v119, v119
    v_cvt_pk_bf16_f32 v18, v116, v117
    v_cvt_pk_bf16_f32 v19, v118, v119
    v_lshlrev_b32 v10, 16, v140
    v_and_b32 v11, 0xffff0000, v140
    v_lshlrev_b32 v12, 16, v141
    v_and_b32 v13, 0xffff0000, v141
    v_cvt_pk_bf16_f32 v120, v120, v120
    v_lshlrev_b32 v120, 16, v120
    v_add_f32 v120, v120, v10
    v_cvt_pk_bf16_f32 v120, v120, v120
    v_lshlrev_b32 v120, 16, v120
    v_max_f32 v120, 0, v120
    v_mul_f32 v120, v120, v120
    v_cvt_pk_bf16_f32 v121, v121, v121
    v_lshlrev_b32 v121, 16, v121
    v_add_f32 v121, v121, v11
    v_cvt_pk_bf16_f32 v121, v121, v121
    v_lshlrev_b32 v121, 16, v121
    v_max_f32 v121, 0, v121
    v_mul_f32 v121, v121, v121
    v_cvt_pk_bf16_f32 v122, v122, v122
    v_lshlrev_b32 v122, 16, v122
    v_add_f32 v122, v122, v12
    v_cvt_pk_bf16_f32 v122, v122, v122
    v_lshlrev_b32 v122, 16, v122
    v_max_f32 v122, 0, v122
    v_mul_f32 v122, v122, v122
    v_cvt_pk_bf16_f32 v123, v123, v123
    v_lshlrev_b32 v123, 16, v123
    v_add_f32 v123, v123, v13
    v_cvt_pk_bf16_f32 v123, v123, v123
    v_lshlrev_b32 v123, 16, v123
    v_max_f32 v123, 0, v123
    v_mul_f32 v123, v123, v123
    v_cvt_pk_bf16_f32 v20, v120, v121
    v_cvt_pk_bf16_f32 v21, v122, v123
    v_lshlrev_b32 v10, 16, v142
    v_and_b32 v11, 0xffff0000, v142
    v_lshlrev_b32 v12, 16, v143
    v_and_b32 v13, 0xffff0000, v143
    v_cvt_pk_bf16_f32 v124, v124, v124
    v_lshlrev_b32 v124, 16, v124
    v_add_f32 v124, v124, v10
    v_cvt_pk_bf16_f32 v124, v124, v124
    v_lshlrev_b32 v124, 16, v124
    v_max_f32 v124, 0, v124
    v_mul_f32 v124, v124, v124
    v_cvt_pk_bf16_f32 v125, v125, v125
    v_lshlrev_b32 v125, 16, v125
    v_add_f32 v125, v125, v11
    v_cvt_pk_bf16_f32 v125, v125, v125
    v_lshlrev_b32 v125, 16, v125
    v_max_f32 v125, 0, v125
    v_mul_f32 v125, v125, v125
    v_cvt_pk_bf16_f32 v126, v126, v126
    v_lshlrev_b32 v126, 16, v126
    v_add_f32 v126, v126, v12
    v_cvt_pk_bf16_f32 v126, v126, v126
    v_lshlrev_b32 v126, 16, v126
    v_max_f32 v126, 0, v126
    v_mul_f32 v126, v126, v126
    v_cvt_pk_bf16_f32 v127, v127, v127
    v_lshlrev_b32 v127, 16, v127
    v_add_f32 v127, v127, v13
    v_cvt_pk_bf16_f32 v127, v127, v127
    v_lshlrev_b32 v127, 16, v127
    v_max_f32 v127, 0, v127
    v_mul_f32 v127, v127, v127
    v_cvt_pk_bf16_f32 v22, v124, v125
    v_cvt_pk_bf16_f32 v23, v126, v127
    s_nop 1
    v_permlane32_swap_b32 v16, v18
    v_permlane32_swap_b32 v17, v19
    v_permlane32_swap_b32 v20, v22
    v_permlane32_swap_b32 v21, v23
    s_add_u32 s69, s67, 1
    s_mul_i32 s69, s69, 112
    s_lshl_b32 s70, s66, 1
    s_add_u32 s69, s69, s70
    s_add_u32 s69, s69, 2
    s_lshl_b32 s69, s69, 10
    buffer_store_dwordx4 v[16:19], v3, s[44:47], s69 offen
    buffer_store_dwordx4 v[20:23], v3, s[44:47], s69 offen offset:1024
    s_nop 1
    s_endpgm
.section .rodata,"a"
.p2align 6
.amdhsa_kernel mid_kernel
  .amdhsa_next_free_vgpr 256
  .amdhsa_next_free_sgpr 102
  .amdhsa_accum_offset 256
  .amdhsa_group_segment_fixed_size 0
  .amdhsa_kernarg_size 120
  .amdhsa_user_sgpr_count 2
  .amdhsa_user_sgpr_kernarg_segment_ptr 1
  .amdhsa_system_sgpr_workgroup_id_x 1
.end_amdhsa_kernel
.text
.globl fin_kernel
.p2align 8
.type fin_kernel,@function
fin_kernel:
    s_load_dwordx16 s[4:19], s[0:1], 0
    s_load_dwordx8 s[20:27], s[0:1], 64
    s_load_dwordx4 s[28:31], s[0:1], 96
    s_load_dwordx2 s[32:33], s[0:1], 112
    s_waitcnt lgkmcnt(0)
    s_cmp_lt_u32 s2, 224
    s_cbranch_scc1 F_GO
    s_endpgm
F_GO:
    s_add_u32 s36, s32, 0x600000
    s_addc_u32 s37, s33, 0
    s_mov_b32 s38, 0x188000
    s_mov_b32 s39, 0x00020000
    s_add_u32 s40, s32, 0xa00000
    s_addc_u32 s41, s33, 0
    s_mov_b32 s42, 0x700000
    s_mov_b32 s43, 0x00020000
    s_add_u32 s44, s32, 0x1200000
    s_addc_u32 s45, s33, 0
    s_mov_b32 s46, 0x1c0000
    s_mov_b32 s47, 0x00020000
    s_mov_b32 s48, s26
    s_mov_b32 s49, s27
    s_mov_b32 s50, 0x380
    s_mov_b32 s51, 0x00020000
    s_mov_b32 s52, s4
    s_mov_b32 s53, s5
    s_mov_b32 s54, 0x1c0000
    s_mov_b32 s55, 0x00020000
    s_mov_b32 s56, s28
    s_mov_b32 s57, s29
    s_mov_b32 s58, 0x1c0000
    s_mov_b32 s59, 0x00020000
    s_mul_hi_u32 s61, s2, 0x24924925
    s_mul_i32 s62, s61, 7
    s_sub_u32 s62, s2, s62
    v_and_b32 v1, 63, v0
    v_lshrrev_b32 v2, 6, v0
    s_nop 0
    v_readfirstlane_b32 s63, v2
    v_lshlrev_b32 v3, 4, v1
    s_mul_i32 s64, s63, 28672
    s_mul_i32 s68, s62, 229376
    s_add_u32 s68, s68, s64
    v_add_u32 v4, s68, v3
    v_add_u32 v5, 114688, v4
    s_mul_i32 s68, s61, 229376
    s_add_u32 s68, s68, s64
    v_add_u32 v6, s68, v3
    v_add_u32 v7, 114688, v6
    v_mov_b32 v64, 0
    v_mov_b32 v65, 0
    v_mov_b32 v66, 0
    v_mov_b32 v67, 0
    v_mov_b32 v68, 0
    v_mov_b32 v69, 0
    v_mov_b32 v70, 0
    v_mov_b32 v71, 0
    v_mov_b32 v72, 0
    v_mov_b32 v73, 0
    v_mov_b32 v74, 0
    v_mov_b32 v75, 0
    v_mov_b32 v76, 0
    v_mov_b32 v77, 0
    v_mov_b32 v78, 0
    v_mov_b32 v79, 0
    v_mov_b32 v80, 0
    v_mov_b32 v81, 0
    v_mov_b32 v82, 0
    v_mov_b32 v83, 0
    v_mov_b32 v84, 0
    v_mov_b32 v85, 0
    v_mov_b32 v86, 0
    v_mov_b32 v87, 0
    v_mov_b32 v88, 0
    v_mov_b32 v89, 0
    v_mov_b32 v90, 0
    v_mov_b32 v91, 0
    v_mov_b32 v92, 0
    v_mov_b32 v93, 0
    v_mov_b32 v94, 0
    v_mov_b32 v95, 0
    v_mov_b32 v96, 0
    v_mov_b32 v97, 0
    v_mov_b32 v98, 0
    v_mov_b32 v99, 0
    v_mov_b32 v100, 0
    v_mov_b32 v101, 0
    v_mov_b32 v102, 0
    v_mov_b32 v103, 0
    v_mov_b32 v104, 0
    v_mov_b32 v105, 0
    v_mov_b32 v106, 0
    v_mov_b32 v107, 0
    v_mov_b32 v108, 0
    v_mov_b32 v109, 0
    v_mov_b32 v110, 0
    v_mov_b32 v111, 0
    v_mov_b32 v112, 0
    v_mov_b32 v113, 0
    v_mov_b32 v114, 0
    v_mov_b32 v115, 0
    v_mov_b32 v116, 0
    v_mov_b32 v117, 0
    v_mov_b32 v118, 0
    v_mov_b32 v119, 0
    v_mov_b32 v120, 0
    v_mov_b32 v121, 0
    v_mov_b32 v122, 0
    v_mov_b32 v123, 0
    v_mov_b32 v124, 0
    v_mov_b32 v125, 0
    v_mov_b32 v126, 0
    v_mov_b32 v127, 0
    s_mov_b32 s70, 0
    buffer_load_dwordx4 v[128:131], v4, s[36:39], s70 offen
    buffer_load_dwordx4 v[132:135], v5, s[36:39], s70 offen
    buffer_load_dwordx4 v[136:139], v6, s[40:43], s70 offen
    buffer_load_dwordx4 v[140:143], v7, s[40:43], s70 offen
    s_mov_b32 s70, 1024
    buffer_load_dwordx4 v[144:147], v4, s[36:39], s70 offen
    buffer_load_dwordx4 v[148:151], v5, s[36:39], s70 offen
    buffer_load_dwordx4 v[152:155], v6, s[40:43], s70 offen
    buffer_load_dwordx4 v[156:159], v7, s[40:43], s70 offen
    s_mov_b32 s70, 2048
    buffer_load_dwordx4 v[160:163], v4, s[36:39], s70 offen
    buffer_load_dwordx4 v[164:167], v5, s[36:39], s70 offen
    buffer_load_dwordx4 v[168:171], v6, s[40:43], s70 offen
    buffer_load_dwordx4 v[172:175], v7, s[40:43], s70 offen
    s_mov_b32 s70, 3072
    buffer_load_dwordx4 v[176:179], v4, s[36:39], s70 offen
    buffer_load_dwordx4 v[180:183], v5, s[36:39], s70 offen
    buffer_load_dwordx4 v[184:187], v6, s[40:43], s70 offen
    buffer_load_dwordx4 v[188:191], v7, s[40:43], s70 offen
    s_mov_b32 s70, 4096
    buffer_load_dwordx4 v[192:195], v4, s[36:39], s70 offen
    buffer_load_dwordx4 v[196:199], v5, s[36:39], s70 offen
    buffer_load_dwordx4 v[200:203], v6, s[40:43], s70 offen
    buffer_load_dwordx4 v[204:207], v7, s[40:43], s70 offen
    s_mov_b32 s70, 5120
    buffer_load_dwordx4 v[208:211], v4, s[36:39], s70 offen
    buffer_load_dwordx4 v[212:215], v5, s[36:39], s70 offen
    buffer_load_dwordx4 v[216:219], v6, s[40:43], s70 offen
    buffer_load_dwordx4 v[220:223], v7, s[40:43], s70 offen
    s_mov_b32 s70, 6144
    buffer_load_dwordx4 v[224:227], v4, s[36:39], s70 offen
    buffer_load_dwordx4 v[228:231], v5, s[36:39], s70 offen
    buffer_load_dwordx4 v[232:235], v6, s[40:43], s70 offen
    buffer_load_dwordx4 v[236:239], v7, s[40:43], s70 offen
    s_mov_b32 s70, 7168
    buffer_load_dwordx4 v[240:243], v4, s[36:39], s70 offen
    buffer_load_dwordx4 v[244:247], v5, s[36:39], s70 offen
    buffer_load_dwordx4 v[248:251], v6, s[40:43], s70 offen
    buffer_load_dwordx4 v[252:255], v7, s[40:43], s70 offen
    s_waitcnt vmcnt(28)
    v_mfma_f32_32x32x16_bf16 v[64:79], v[128:131], v[136:139], v[64:79]
    v_mfma_f32_32x32x16_bf16 v[80:95], v[128:131], v[140:143], v[80:95]
    v_mfma_f32_32x32x16_bf16 v[96:111], v[132:135], v[136:139], v[96:111]
    v_mfma_f32_32x32x16_bf16 v[112:127], v[132:135], v[140:143], v[112:127]
    s_mov_b32 s70, 8192
    buffer_load_dwordx4 v[128:131], v4, s[36:39], s70 offen
    buffer_load_dwordx4 v[132:135], v5, s[36:39], s70 offen
    buffer_load_dwordx4 v[136:139], v6, s[40:43], s70 offen
    buffer_load_dwordx4 v[140:143], v7, s[40:43], s70 offen
    s_waitcnt vmcnt(28)
    v_mfma_f32_32x32x16_bf16 v[64:79], v[144:147], v[152:155], v[64:79]
    v_mfma_f32_32x32x16_bf16 v[80:95], v[144:147], v[156:159], v[80:95]
    v_mfma_f32_32x32x16_bf16 v[96:111], v[148:151], v[152:155], v[96:111]
    v_mfma_f32_32x32x16_bf16 v[112:127], v[148:151], v[156:159], v[112:127]
    s_mov_b32 s70, 9216
    buffer_load_dwordx4 v[144:147], v4, s[36:39], s70 offen
    buffer_load_dwordx4 v[148:151], v5, s[36:39], s70 offen
    buffer_load_dwordx4 v[152:155], v6, s[40:43], s70 offen
    buffer_load_dwordx4 v[156:159], v7, s[40:43], s70 offen
    s_waitcnt vmcnt(28)
    v_mfma_f32_32x32x16_bf16 v[64:79], v[160:163], v[168:171], v[64:79]
    v_mfma_f32_32x32x16_bf16 v[80:95], v[160:163], v[172:175], v[80:95]
    v_mfma_f32_32x32x16_bf16 v[96:111], v[164:167], v[168:171], v[96:111]
    v_mfma_f32_32x32x16_bf16 v[112:127], v[164:167], v[172:175], v[112:127]
    s_mov_b32 s70, 10240
    buffer_load_dwordx4 v[160:163], v4, s[36:39], s70 offen
    buffer_load_dwordx4 v[164:167], v5, s[36:39], s70 offen
    buffer_load_dwordx4 v[168:171], v6, s[40:43], s70 offen
    buffer_load_dwordx4 v[172:175], v7, s[40:43], s70 offen
    s_waitcnt vmcnt(28)
    v_mfma_f32_32x32x16_bf16 v[64:79], v[176:179], v[184:187], v[64:79]
    v_mfma_f32_32x32x16_bf16 v[80:95], v[176:179], v[188:191], v[80:95]
    v_mfma_f32_32x32x16_bf16 v[96:111], v[180:183], v[184:187], v[96:111]
    v_mfma_f32_32x32x16_bf16 v[112:127], v[180:183], v[188:191], v[112:127]
    s_mov_b32 s70, 11264
    buffer_load_dwordx4 v[176:179], v4, s[36:39], s70 offen
    buffer_load_dwordx4 v[180:183], v5, s[36:39], s70 offen
    buffer_load_dwordx4 v[184:187], v6, s[40:43], s70 offen
    buffer_load_dwordx4 v[188:191], v7, s[40:43], s70 offen
    s_waitcnt vmcnt(28)
    v_mfma_f32_32x32x16_bf16 v[64:79], v[192:195], v[200:203], v[64:79]
    v_mfma_f32_32x32x16_bf16 v[80:95], v[192:195], v[204:207], v[80:95]
    v_mfma_f32_32x32x16_bf16 v[96:111], v[196:199], v[200:203], v[96:111]
    v_mfma_f32_32x32x16_bf16 v[112:127], v[196:199], v[204:207], v[112:127]
    s_mov_b32 s70, 12288
    buffer_load_dwordx4 v[192:195], v4, s[36:39], s70 offen
    buffer_load_dwordx4 v[196:199], v5, s[36:39], s70 offen
    buffer_load_dwordx4 v[200:203], v6, s[40:43], s70 offen
    buffer_load_dwordx4 v[204:207], v7, s[40:43], s70 offen
    s_waitcnt vmcnt(28)
    v_mfma_f32_32x32x16_bf16 v[64:79], v[208:211], v[216:219], v[64:79]
    v_mfma_f32_32x32x16_bf16 v[80:95], v[208:211], v[220:223], v[80:95]
    v_mfma_f32_32x32x16_bf16 v[96:111], v[212:215], v[216:219], v[96:111]
    v_mfma_f32_32x32x16_bf16 v[112:127], v[212:215], v[220:223], v[112:127]
    s_mov_b32 s70, 13312
    buffer_load_dwordx4 v[208:211], v4, s[36:39], s70 offen
    buffer_load_dwordx4 v[212:215], v5, s[36:39], s70 offen
    buffer_load_dwordx4 v[216:219], v6, s[40:43], s70 offen
    buffer_load_dwordx4 v[220:223], v7, s[40:43], s70 offen
    s_waitcnt vmcnt(28)
    v_mfma_f32_32x32x16_bf16 v[64:79], v[224:227], v[232:235], v[64:79]
    v_mfma_f32_32x32x16_bf16 v[80:95], v[224:227], v[236:239], v[80:95]
    v_mfma_f32_32x32x16_bf16 v[96:111], v[228:231], v[232:235], v[96:111]
    v_mfma_f32_32x32x16_bf16 v[112:127], v[228:231], v[236:239], v[112:127]
    s_mov_b32 s70, 14336
    buffer_load_dwordx4 v[224:227], v4, s[36:39], s70 offen
    buffer_load_dwordx4 v[228:231], v5, s[36:39], s70 offen
    buffer_load_dwordx4 v[232:235], v6, s[40:43], s70 offen
    buffer_load_dwordx4 v[236:239], v7, s[40:43], s70 offen
    s_waitcnt vmcnt(28)
    v_mfma_f32_32x32x16_bf16 v[64:79], v[240:243], v[248:251], v[64:79]
    v_mfma_f32_32x32x16_bf16 v[80:95], v[240:243], v[252:255], v[80:95]
    v_mfma_f32_32x32x16_bf16 v[96:111], v[244:247], v[248:251], v[96:111]
    v_mfma_f32_32x32x16_bf16 v[112:127], v[244:247], v[252:255], v[112:127]
    s_mov_b32 s70, 15360
    buffer_load_dwordx4 v[240:243], v4, s[36:39], s70 offen
    buffer_load_dwordx4 v[244:247], v5, s[36:39], s70 offen
    buffer_load_dwordx4 v[248:251], v6, s[40:43], s70 offen
    buffer_load_dwordx4 v[252:255], v7, s[40:43], s70 offen
    s_waitcnt vmcnt(28)
    v_mfma_f32_32x32x16_bf16 v[64:79], v[128:131], v[136:139], v[64:79]
    v_mfma_f32_32x32x16_bf16 v[80:95], v[128:131], v[140:143], v[80:95]
    v_mfma_f32_32x32x16_bf16 v[96:111], v[132:135], v[136:139], v[96:111]
    v_mfma_f32_32x32x16_bf16 v[112:127], v[132:135], v[140:143], v[112:127]
    s_mov_b32 s70, 16384
    buffer_load_dwordx4 v[128:131], v4, s[36:39], s70 offen
    buffer_load_dwordx4 v[132:135], v5, s[36:39], s70 offen
    buffer_load_dwordx4 v[136:139], v6, s[40:43], s70 offen
    buffer_load_dwordx4 v[140:143], v7, s[40:43], s70 offen
    s_waitcnt vmcnt(28)
    v_mfma_f32_32x32x16_bf16 v[64:79], v[144:147], v[152:155], v[64:79]
    v_mfma_f32_32x32x16_bf16 v[80:95], v[144:147], v[156:159], v[80:95]
    v_mfma_f32_32x32x16_bf16 v[96:111], v[148:151], v[152:155], v[96:111]
    v_mfma_f32_32x32x16_bf16 v[112:127], v[148:151], v[156:159], v[112:127]
    s_mov_b32 s70, 17408
    buffer_load_dwordx4 v[144:147], v4, s[36:39], s70 offen
    buffer_load_dwordx4 v[148:151], v5, s[36:39], s70 offen
    buffer_load_dwordx4 v[152:155], v6, s[40:43], s70 offen
    buffer_load_dwordx4 v[156:159], v7, s[40:43], s70 offen
    s_waitcnt vmcnt(28)
    v_mfma_f32_32x32x16_bf16 v[64:79], v[160:163], v[168:171], v[64:79]
    v_mfma_f32_32x32x16_bf16 v[80:95], v[160:163], v[172:175], v[80:95]
    v_mfma_f32_32x32x16_bf16 v[96:111], v[164:167], v[168:171], v[96:111]
    v_mfma_f32_32x32x16_bf16 v[112:127], v[164:167], v[172:175], v[112:127]
    s_mov_b32 s70, 18432
    buffer_load_dwordx4 v[160:163], v4, s[36:39], s70 offen
    buffer_load_dwordx4 v[164:167], v5, s[36:39], s70 offen
    buffer_load_dwordx4 v[168:171], v6, s[40:43], s70 offen
    buffer_load_dwordx4 v[172:175], v7, s[40:43], s70 offen
    s_waitcnt vmcnt(28)
    v_mfma_f32_32x32x16_bf16 v[64:79], v[176:179], v[184:187], v[64:79]
    v_mfma_f32_32x32x16_bf16 v[80:95], v[176:179], v[188:191], v[80:95]
    v_mfma_f32_32x32x16_bf16 v[96:111], v[180:183], v[184:187], v[96:111]
    v_mfma_f32_32x32x16_bf16 v[112:127], v[180:183], v[188:191], v[112:127]
    s_mov_b32 s70, 19456
    buffer_load_dwordx4 v[176:179], v4, s[36:39], s70 offen
    buffer_load_dwordx4 v[180:183], v5, s[36:39], s70 offen
    buffer_load_dwordx4 v[184:187], v6, s[40:43], s70 offen
    buffer_load_dwordx4 v[188:191], v7, s[40:43], s70 offen
    s_waitcnt vmcnt(28)
    v_mfma_f32_32x32x16_bf16 v[64:79], v[192:195], v[200:203], v[64:79]
    v_mfma_f32_32x32x16_bf16 v[80:95], v[192:195], v[204:207], v[80:95]
    v_mfma_f32_32x32x16_bf16 v[96:111], v[196:199], v[200:203], v[96:111]
    v_mfma_f32_32x32x16_bf16 v[112:127], v[196:199], v[204:207], v[112:127]
    s_mov_b32 s70, 20480
    buffer_load_dwordx4 v[192:195], v4, s[36:39], s70 offen
    buffer_load_dwordx4 v[196:199], v5, s[36:39], s70 offen
    buffer_load_dwordx4 v[200:203], v6, s[40:43], s70 offen
    buffer_load_dwordx4 v[204:207], v7, s[40:43], s70 offen
    s_waitcnt vmcnt(28)
    v_mfma_f32_32x32x16_bf16 v[64:79], v[208:211], v[216:219], v[64:79]
    v_mfma_f32_32x32x16_bf16 v[80:95], v[208:211], v[220:223], v[80:95]
    v_mfma_f32_32x32x16_bf16 v[96:111], v[212:215], v[216:219], v[96:111]
    v_mfma_f32_32x32x16_bf16 v[112:127], v[212:215], v[220:223], v[112:127]
    s_mov_b32 s70, 21504
    buffer_load_dwordx4 v[208:211], v4, s[36:39], s70 offen
    buffer_load_dwordx4 v[212:215], v5, s[36:39], s70 offen
    buffer_load_dwordx4 v[216:219], v6, s[40:43], s70 offen
    buffer_load_dwordx4 v[220:223], v7, s[40:43], s70 offen
    s_waitcnt vmcnt(28)
    v_mfma_f32_32x32x16_bf16 v[64:79], v[224:227], v[232:235], v[64:79]
    v_mfma_f32_32x32x16_bf16 v[80:95], v[224:227], v[236:239], v[80:95]
    v_mfma_f32_32x32x16_bf16 v[96:111], v[228:231], v[232:235], v[96:111]
    v_mfma_f32_32x32x16_bf16 v[112:127], v[228:231], v[236:239], v[112:127]
    s_mov_b32 s70, 22528
    buffer_load_dwordx4 v[224:227], v4, s[36:39], s70 offen
    buffer_load_dwordx4 v[228:231], v5, s[36:39], s70 offen
    buffer_load_dwordx4 v[232:235], v6, s[40:43], s70 offen
    buffer_load_dwordx4 v[236:239], v7, s[40:43], s70 offen
    s_waitcnt vmcnt(28)
    v_mfma_f32_32x32x16_bf16 v[64:79], v[240:243], v[248:251], v[64:79]
    v_mfma_f32_32x32x16_bf16 v[80:95], v[240:243], v[252:255], v[80:95]
    v_mfma_f32_32x32x16_bf16 v[96:111], v[244:247], v[248:251], v[96:111]
    v_mfma_f32_32x32x16_bf16 v[112:127], v[244:247], v[252:255], v[112:127]
    s_mov_b32 s70, 23552
    buffer_load_dwordx4 v[240:243], v4, s[36:39], s70 offen
    buffer_load_dwordx4 v[244:247], v5, s[36:39], s70 offen
    buffer_load_dwordx4 v[248:251], v6, s[40:43], s70 offen
    buffer_load_dwordx4 v[252:255], v7, s[40:43], s70 offen
    s_waitcnt vmcnt(28)
    v_mfma_f32_32x32x16_bf16 v[64:79], v[128:131], v[136:139], v[64:79]
    v_mfma_f32_32x32x16_bf16 v[80:95], v[128:131], v[140:143], v[80:95]
    v_mfma_f32_32x32x16_bf16 v[96:111], v[132:135], v[136:139], v[96:111]
    v_mfma_f32_32x32x16_bf16 v[112:127], v[132:135], v[140:143], v[112:127]
    s_mov_b32 s70, 24576
    buffer_load_dwordx4 v[128:131], v4, s[36:39], s70 offen
    buffer_load_dwordx4 v[132:135], v5, s[36:39], s70 offen
    buffer_load_dwordx4 v[136:139], v6, s[40:43], s70 offen
    buffer_load_dwordx4 v[140:143], v7, s[40:43], s70 offen
    s_waitcnt vmcnt(28)
    v_mfma_f32_32x32x16_bf16 v[64:79], v[144:147], v[152:155], v[64:79]
    v_mfma_f32_32x32x16_bf16 v[80:95], v[144:147], v[156:159], v[80:95]
    v_mfma_f32_32x32x16_bf16 v[96:111], v[148:151], v[152:155], v[96:111]
    v_mfma_f32_32x32x16_bf16 v[112:127], v[148:151], v[156:159], v[112:127]
    s_mov_b32 s70, 25600
    buffer_load_dwordx4 v[144:147], v4, s[36:39], s70 offen
    buffer_load_dwordx4 v[148:151], v5, s[36:39], s70 offen
    buffer_load_dwordx4 v[152:155], v6, s[40:43], s70 offen
    buffer_load_dwordx4 v[156:159], v7, s[40:43], s70 offen
    s_waitcnt vmcnt(28)
    v_mfma_f32_32x32x16_bf16 v[64:79], v[160:163], v[168:171], v[64:79]
    v_mfma_f32_32x32x16_bf16 v[80:95], v[160:163], v[172:175], v[80:95]
    v_mfma_f32_32x32x16_bf16 v[96:111], v[164:167], v[168:171], v[96:111]
    v_mfma_f32_32x32x16_bf16 v[112:127], v[164:167], v[172:175], v[112:127]
    s_mov_b32 s70, 26624
    buffer_load_dwordx4 v[160:163], v4, s[36:39], s70 offen
    buffer_load_dwordx4 v[164:167], v5, s[36:39], s70 offen
    buffer_load_dwordx4 v[168:171], v6, s[40:43], s70 offen
    buffer_load_dwordx4 v[172:175], v7, s[40:43], s70 offen
    s_waitcnt vmcnt(28)
    v_mfma_f32_32x32x16_bf16 v[64:79], v[176:179], v[184:187], v[64:79]
    v_mfma_f32_32x32x16_bf16 v[80:95], v[176:179], v[188:191], v[80:95]
    v_mfma_f32_32x32x16_bf16 v[96:111], v[180:183], v[184:187], v[96:111]
    v_mfma_f32_32x32x16_bf16 v[112:127], v[180:183], v[188:191], v[112:127]
    s_mov_b32 s70, 27648
    buffer_load_dwordx4 v[176:179], v4, s[36:39], s70 offen
    buffer_load_dwordx4 v[180:183], v5, s[36:39], s70 offen
    buffer_load_dwordx4 v[184:187], v6, s[40:43], s70 offen
    buffer_load_dwordx4 v[188:191], v7, s[40:43], s70 offen
    s_waitcnt vmcnt(28)
    v_mfma_f32_32x32x16_bf16 v[64:79], v[192:195], v[200:203], v[64:79]
    v_mfma_f32_32x32x16_bf16 v[80:95], v[192:195], v[204:207], v[80:95]
    v_mfma_f32_32x32x16_bf16 v[96:111], v[196:199], v[200:203], v[96:111]
    v_mfma_f32_32x32x16_bf16 v[112:127], v[196:199], v[204:207], v[112:127]
    s_waitcnt vmcnt(24)
    v_mfma_f32_32x32x16_bf16 v[64:79], v[208:211], v[216:219], v[64:79]
    v_mfma_f32_32x32x16_bf16 v[80:95], v[208:211], v[220:223], v[80:95]
    v_mfma_f32_32x32x16_bf16 v[96:111], v[212:215], v[216:219], v[96:111]
    v_mfma_f32_32x32x16_bf16 v[112:127], v[212:215], v[220:223], v[112:127]
    s_waitcnt vmcnt(20)
    v_mfma_f32_32x32x16_bf16 v[64:79], v[224:227], v[232:235], v[64:79]
    v_mfma_f32_32x32x16_bf16 v[80:95], v[224:227], v[236:239], v[80:95]
    v_mfma_f32_32x32x16_bf16 v[96:111], v[228:231], v[232:235], v[96:111]
    v_mfma_f32_32x32x16_bf16 v[112:127], v[228:231], v[236:239], v[112:127]
    s_waitcnt vmcnt(16)
    v_mfma_f32_32x32x16_bf16 v[64:79], v[240:243], v[248:251], v[64:79]
    v_mfma_f32_32x32x16_bf16 v[80:95], v[240:243], v[252:255], v[80:95]
    v_mfma_f32_32x32x16_bf16 v[96:111], v[244:247], v[248:251], v[96:111]
    v_mfma_f32_32x32x16_bf16 v[112:127], v[244:247], v[252:255], v[112:127]
    s_waitcnt vmcnt(12)
    v_mfma_f32_32x32x16_bf16 v[64:79], v[128:131], v[136:139], v[64:79]
    v_mfma_f32_32x32x16_bf16 v[80:95], v[128:131], v[140:143], v[80:95]
    v_mfma_f32_32x32x16_bf16 v[96:111], v[132:135], v[136:139], v[96:111]
    v_mfma_f32_32x32x16_bf16 v[112:127], v[132:135], v[140:143], v[112:127]
    s_waitcnt vmcnt(8)
    v_mfma_f32_32x32x16_bf16 v[64:79], v[144:147], v[152:155], v[64:79]
    v_mfma_f32_32x32x16_bf16 v[80:95], v[144:147], v[156:159], v[80:95]
    v_mfma_f32_32x32x16_bf16 v[96:111], v[148:151], v[152:155], v[96:111]
    v_mfma_f32_32x32x16_bf16 v[112:127], v[148:151], v[156:159], v[112:127]
    s_waitcnt vmcnt(4)
    v_mfma_f32_32x32x16_bf16 v[64:79], v[160:163], v[168:171], v[64:79]
    v_mfma_f32_32x32x16_bf16 v[80:95], v[160:163], v[172:175], v[80:95]
    v_mfma_f32_32x32x16_bf16 v[96:111], v[164:167], v[168:171], v[96:111]
    v_mfma_f32_32x32x16_bf16 v[112:127], v[164:167], v[172:175], v[112:127]
    s_waitcnt vmcnt(0)
    v_mfma_f32_32x32x16_bf16 v[64:79], v[176:179], v[184:187], v[64:79]
    v_mfma_f32_32x32x16_bf16 v[80:95], v[176:179], v[188:191], v[80:95]
    v_mfma_f32_32x32x16_bf16 v[96:111], v[180:183], v[184:187], v[96:111]
    v_mfma_f32_32x32x16_bf16 v[112:127], v[180:183], v[188:191], v[112:127]
    s_nop 15
    v_lshlrev_b32 v8, 4, v1
    s_lshl_b32 s70, s63, 12
    s_add_u32 s70, s70, 0
    v_add_u32 v9, s70, v8
    ds_write_b128 v9, v[64:67] offset:0
    ds_write_b128 v9, v[68:71] offset:1024
    ds_write_b128 v9, v[72:75] offset:2048
    ds_write_b128 v9, v[76:79] offset:3072
    s_lshl_b32 s70, s63, 12
    s_add_u32 s70, s70, 16384
    v_add_u32 v9, s70, v8
    ds_write_b128 v9, v[80:83] offset:0
    ds_write_b128 v9, v[84:87] offset:1024
    ds_write_b128 v9, v[88:91] offset:2048
    ds_write_b128 v9, v[92:95] offset:3072
    s_lshl_b32 s70, s63, 12
    s_add_u32 s70, s70, 32768
    v_add_u32 v9, s70, v8
    ds_write_b128 v9, v[96:99] offset:0
    ds_write_b128 v9, v[100:103] offset:1024
    ds_write_b128 v9, v[104:107] offset:2048
    ds_write_b128 v9, v[108:111] offset:3072
    s_lshl_b32 s70, s63, 12
    s_add_u32 s70, s70, 49152
    v_add_u32 v9, s70, v8
    ds_write_b128 v9, v[112:115] offset:0
    ds_write_b128 v9, v[116:119] offset:1024
    ds_write_b128 v9, v[120:123] offset:2048
    ds_write_b128 v9, v[124:127] offset:3072
    s_waitcnt lgkmcnt(0)
    s_barrier
    s_lshl_b32 s70, s63, 14
    v_add_u32 v9, s70, v8
    ds_read_b128 v[128:131], v9 offset:0
    ds_read_b128 v[132:135], v9 offset:1024
    ds_read_b128 v[136:139], v9 offset:2048
    ds_read_b128 v[140:143], v9 offset:3072
    ds_read_b128 v[144:147], v9 offset:4096
    ds_read_b128 v[148:151], v9 offset:5120
    ds_read_b128 v[152:155], v9 offset:6144
    ds_read_b128 v[156:159], v9 offset:7168
    ds_read_b128 v[160:163], v9 offset:8192
    ds_read_b128 v[164:167], v9 offset:9216
    ds_read_b128 v[168:171], v9 offset:10240
    ds_read_b128 v[172:175], v9 offset:11264
    ds_read_b128 v[176:179], v9 offset:12288
    ds_read_b128 v[180:183], v9 offset:13312
    ds_read_b128 v[184:187], v9 offset:14336
    ds_read_b128 v[188:191], v9 offset:15360
    s_waitcnt lgkmcnt(0)
    v_add_f32 v64, v128, v144
    v_add_f32 v80, v160, v176
    v_add_f32 v64, v64, v80
    v_add_f32 v65, v129, v145
    v_add_f32 v81, v161, v177
    v_add_f32 v65, v65, v81
    v_add_f32 v66, v130, v146
    v_add_f32 v82, v162, v178
    v_add_f32 v66, v66, v82
    v_add_f32 v67, v131, v147
    v_add_f32 v83, v163, v179
    v_add_f32 v67, v67, v83
    v_add_f32 v68, v132, v148
    v_add_f32 v84, v164, v180
    v_add_f32 v68, v68, v84
    v_add_f32 v69, v133, v149
    v_add_f32 v85, v165, v181
    v_add_f32 v69, v69, v85
    v_add_f32 v70, v134, v150
    v_add_f32 v86, v166, v182
    v_add_f32 v70, v70, v86
    v_add_f32 v71, v135, v151
    v_add_f32 v87, v167, v183
    v_add_f32 v71, v71, v87
    v_add_f32 v72, v136, v152
    v_add_f32 v88, v168, v184
    v_add_f32 v72, v72, v88
    v_add_f32 v73, v137, v153
    v_add_f32 v89, v169, v185
    v_add_f32 v73, v73, v89
    v_add_f32 v74, v138, v154
    v_add_f32 v90, v170, v186
    v_add_f32 v74, v74, v90
    v_add_f32 v75, v139, v155
    v_add_f32 v91, v171, v187
    v_add_f32 v75, v75, v91
    v_add_f32 v76, v140, v156
    v_add_f32 v92, v172, v188
    v_add_f32 v76, v76, v92
    v_add_f32 v77, v141, v157
    v_add_f32 v93, v173, v189
    v_add_f32 v77, v77, v93
    v_add_f32 v78, v142, v158
    v_add_f32 v94, v174, v190
    v_add_f32 v78, v78, v94
    v_add_f32 v79, v143, v159
    v_add_f32 v95, v175, v191
    v_add_f32 v79, v79, v95
    s_lshr_b32 s64, s63, 1
    s_and_b32 s65, s63, 1
    s_lshl_b32 s66, s62, 6
    s_lshl_b32 s64, s64, 5
    s_add_u32 s66, s66, s64
    s_lshl_b32 s67, s61, 6
    s_lshl_b32 s65, s65, 5
    s_add_u32 s67, s67, s65
    v_and_b32 v10, 31, v1
    v_lshrrev_b32 v11, 5, v1
    v_add_u32 v12, s67, v10
    v_lshlrev_b32 v13, 2, v11
    v_add_u32 v13, s66, v13
    v_mul_u32_u24 v14, 896, v12
    v_lshlrev_b32 v15, 1, v13
    v_add_u32 v14, v14, v15
    v_lshlrev_b32 v16, 12, v13
    v_lshlrev_b32 v17, 1, v12
    v_add_u32 v16, v16, v17
    buffer_load_dwordx2 v[128:129], v14, s[52:55], 0 offen offset:0
    buffer_load_dwordx2 v[136:137], v15, s[48:51], 0 offen offset:0
    s_mov_b32 s70, 0
    buffer_load_ushort v144, v16, s[44:47], s70 offen
    s_mov_b32 s70, 4096
    buffer_load_ushort v145, v16, s[44:47], s70 offen
    s_mov_b32 s70, 8192
    buffer_load_ushort v146, v16, s[44:47], s70 offen
    s_mov_b32 s70, 12288
    buffer_load_ushort v147, v16, s[44:47], s70 offen
    buffer_load_dwordx2 v[130:131], v14, s[52:55], 0 offen offset:16
    buffer_load_dwordx2 v[138:139], v15, s[48:51], 0 offen offset:16
    s_mov_b32 s70, 32768
    buffer_load_ushort v148, v16, s[44:47], s70 offen
    s_mov_b32 s70, 36864
    buffer_load_ushort v149, v16, s[44:47], s70 offen
    s_mov_b32 s70, 40960
    buffer_load_ushort v150, v16, s[44:47], s70 offen
    s_mov_b32 s70, 45056
    buffer_load_ushort v151, v16, s[44:47], s70 offen
    buffer_load_dwordx2 v[132:133], v14, s[52:55], 0 offen offset:32
    buffer_load_dwordx2 v[140:141], v15, s[48:51], 0 offen offset:32
    s_mov_b32 s70, 65536
    buffer_load_ushort v152, v16, s[44:47], s70 offen
    s_mov_b32 s70, 69632
    buffer_load_ushort v153, v16, s[44:47], s70 offen
    s_mov_b32 s70, 73728
    buffer_load_ushort v154, v16, s[44:47], s70 offen
    s_mov_b32 s70, 77824
    buffer_load_ushort v155, v16, s[44:47], s70 offen
    buffer_load_dwordx2 v[134:135], v14, s[52:55], 0 offen offset:48
    buffer_load_dwordx2 v[142:143], v15, s[48:51], 0 offen offset:48
    s_mov_b32 s70, 98304
    buffer_load_ushort v156, v16, s[44:47], s70 offen
    s_mov_b32 s70, 102400
    buffer_load_ushort v157, v16, s[44:47], s70 offen
    s_mov_b32 s70, 106496
    buffer_load_ushort v158, v16, s[44:47], s70 offen
    s_mov_b32 s70, 110592
    buffer_load_ushort v159, v16, s[44:47], s70 offen
    s_waitcnt vmcnt(0)
    v_lshlrev_b32 v20, 16, v128
    v_and_b32 v21, 0xffff0000, v128
    v_lshlrev_b32 v22, 16, v129
    v_and_b32 v23, 0xffff0000, v129
    v_lshlrev_b32 v24, 16, v136
    v_and_b32 v25, 0xffff0000, v136
    v_lshlrev_b32 v26, 16, v137
    v_and_b32 v27, 0xffff0000, v137
    v_cvt_pk_bf16_f32 v64, v64, v64
    v_lshlrev_b32 v64, 16, v64
    v_add_f32 v64, v64, v24
    v_cvt_pk_bf16_f32 v64, v64, v64
    v_lshlrev_b32 v64, 16, v64
    v_mul_f32 v28, 0xbfb8aa3b, v64
    v_exp_f32 v28, v28
    s_nop 0
    v_add_f32 v28, 1.0, v28
    v_rcp_f32 v28, v28
    s_nop 0
    v_mul_f32 v64, v64, v28
    v_cvt_pk_bf16_f32 v64, v64, v64
    v_lshlrev_b32 v64, 16, v64
    v_lshlrev_b32 v29, 16, v144
    v_mul_f32 v64, v64, v29
    v_cvt_pk_bf16_f32 v64, v64, v64
    v_lshlrev_b32 v64, 16, v64
    v_add_f32 v64, v64, v20
    v_cvt_pk_bf16_f32 v65, v65, v65
    v_lshlrev_b32 v65, 16, v65
    v_add_f32 v65, v65, v25
    v_cvt_pk_bf16_f32 v65, v65, v65
    v_lshlrev_b32 v65, 16, v65
    v_mul_f32 v28, 0xbfb8aa3b, v65
    v_exp_f32 v28, v28
    s_nop 0
    v_add_f32 v28, 1.0, v28
    v_rcp_f32 v28, v28
    s_nop 0
    v_mul_f32 v65, v65, v28
    v_cvt_pk_bf16_f32 v65, v65, v65
    v_lshlrev_b32 v65, 16, v65
    v_lshlrev_b32 v29, 16, v145
    v_mul_f32 v65, v65, v29
    v_cvt_pk_bf16_f32 v65, v65, v65
    v_lshlrev_b32 v65, 16, v65
    v_add_f32 v65, v65, v21
    v_cvt_pk_bf16_f32 v66, v66, v66
    v_lshlrev_b32 v66, 16, v66
    v_add_f32 v66, v66, v26
    v_cvt_pk_bf16_f32 v66, v66, v66
    v_lshlrev_b32 v66, 16, v66
    v_mul_f32 v28, 0xbfb8aa3b, v66
    v_exp_f32 v28, v28
    s_nop 0
    v_add_f32 v28, 1.0, v28
    v_rcp_f32 v28, v28
    s_nop 0
    v_mul_f32 v66, v66, v28
    v_cvt_pk_bf16_f32 v66, v66, v66
    v_lshlrev_b32 v66, 16, v66
    v_lshlrev_b32 v29, 16, v146
    v_mul_f32 v66, v66, v29
    v_cvt_pk_bf16_f32 v66, v66, v66
    v_lshlrev_b32 v66, 16, v66
    v_add_f32 v66, v66, v22
    v_cvt_pk_bf16_f32 v67, v67, v67
    v_lshlrev_b32 v67, 16, v67
    v_add_f32 v67, v67, v27
    v_cvt_pk_bf16_f32 v67, v67, v67
    v_lshlrev_b32 v67, 16, v67
    v_mul_f32 v28, 0xbfb8aa3b, v67
    v_exp_f32 v28, v28
    s_nop 0
    v_add_f32 v28, 1.0, v28
    v_rcp_f32 v28, v28
    s_nop 0
    v_mul_f32 v67, v67, v28
    v_cvt_pk_bf16_f32 v67, v67, v67
    v_lshlrev_b32 v67, 16, v67
    v_lshlrev_b32 v29, 16, v147
    v_mul_f32 v67, v67, v29
    v_cvt_pk_bf16_f32 v67, v67, v67
    v_lshlrev_b32 v67, 16, v67
    v_add_f32 v67, v67, v23
    v_cvt_pk_bf16_f32 v30, v64, v65
    v_cvt_pk_bf16_f32 v31, v66, v67
    buffer_store_dwordx2 v[30:31], v14, s[56:59], 0 offen offset:0
    v_lshlrev_b32 v20, 16, v130
    v_and_b32 v21, 0xffff0000, v130
    v_lshlrev_b32 v22, 16, v131
    v_and_b32 v23, 0xffff0000, v131
    v_lshlrev_b32 v24, 16, v138
    v_and_b32 v25, 0xffff0000, v138
    v_lshlrev_b32 v26, 16, v139
    v_and_b32 v27, 0xffff0000, v139
    v_cvt_pk_bf16_f32 v68, v68, v68
    v_lshlrev_b32 v68, 16, v68
    v_add_f32 v68, v68, v24
    v_cvt_pk_bf16_f32 v68, v68, v68
    v_lshlrev_b32 v68, 16, v68
    v_mul_f32 v28, 0xbfb8aa3b, v68
    v_exp_f32 v28, v28
    s_nop 0
    v_add_f32 v28, 1.0, v28
    v_rcp_f32 v28, v28
    s_nop 0
    v_mul_f32 v68, v68, v28
    v_cvt_pk_bf16_f32 v68, v68, v68
    v_lshlrev_b32 v68, 16, v68
    v_lshlrev_b32 v29, 16, v148
    v_mul_f32 v68, v68, v29
    v_cvt_pk_bf16_f32 v68, v68, v68
    v_lshlrev_b32 v68, 16, v68
    v_add_f32 v68, v68, v20
    v_cvt_pk_bf16_f32 v69, v69, v69
    v_lshlrev_b32 v69, 16, v69
    v_add_f32 v69, v69, v25
    v_cvt_pk_bf16_f32 v69, v69, v69
    v_lshlrev_b32 v69, 16, v69
    v_mul_f32 v28, 0xbfb8aa3b, v69
    v_exp_f32 v28, v28
    s_nop 0
    v_add_f32 v28, 1.0, v28
    v_rcp_f32 v28, v28
    s_nop 0
    v_mul_f32 v69, v69, v28
    v_cvt_pk_bf16_f32 v69, v69, v69
    v_lshlrev_b32 v69, 16, v69
    v_lshlrev_b32 v29, 16, v149
    v_mul_f32 v69, v69, v29
    v_cvt_pk_bf16_f32 v69, v69, v69
    v_lshlrev_b32 v69, 16, v69
    v_add_f32 v69, v69, v21
    v_cvt_pk_bf16_f32 v70, v70, v70
    v_lshlrev_b32 v70, 16, v70
    v_add_f32 v70, v70, v26
    v_cvt_pk_bf16_f32 v70, v70, v70
    v_lshlrev_b32 v70, 16, v70
    v_mul_f32 v28, 0xbfb8aa3b, v70
    v_exp_f32 v28, v28
    s_nop 0
    v_add_f32 v28, 1.0, v28
    v_rcp_f32 v28, v28
    s_nop 0
    v_mul_f32 v70, v70, v28
    v_cvt_pk_bf16_f32 v70, v70, v70
    v_lshlrev_b32 v70, 16, v70
    v_lshlrev_b32 v29, 16, v150
    v_mul_f32 v70, v70, v29
    v_cvt_pk_bf16_f32 v70, v70, v70
    v_lshlrev_b32 v70, 16, v70
    v_add_f32 v70, v70, v22
    v_cvt_pk_bf16_f32 v71, v71, v71
    v_lshlrev_b32 v71, 16, v71
    v_add_f32 v71, v71, v27
    v_cvt_pk_bf16_f32 v71, v71, v71
    v_lshlrev_b32 v71, 16, v71
    v_mul_f32 v28, 0xbfb8aa3b, v71
    v_exp_f32 v28, v28
    s_nop 0
    v_add_f32 v28, 1.0, v28
    v_rcp_f32 v28, v28
    s_nop 0
    v_mul_f32 v71, v71, v28
    v_cvt_pk_bf16_f32 v71, v71, v71
    v_lshlrev_b32 v71, 16, v71
    v_lshlrev_b32 v29, 16, v151
    v_mul_f32 v71, v71, v29
    v_cvt_pk_bf16_f32 v71, v71, v71
    v_lshlrev_b32 v71, 16, v71
    v_add_f32 v71, v71, v23
    v_cvt_pk_bf16_f32 v32, v68, v69
    v_cvt_pk_bf16_f32 v33, v70, v71
    buffer_store_dwordx2 v[32:33], v14, s[56:59], 0 offen offset:16
    v_lshlrev_b32 v20, 16, v132
    v_and_b32 v21, 0xffff0000, v132
    v_lshlrev_b32 v22, 16, v133
    v_and_b32 v23, 0xffff0000, v133
    v_lshlrev_b32 v24, 16, v140
    v_and_b32 v25, 0xffff0000, v140
    v_lshlrev_b32 v26, 16, v141
    v_and_b32 v27, 0xffff0000, v141
    v_cvt_pk_bf16_f32 v72, v72, v72
    v_lshlrev_b32 v72, 16, v72
    v_add_f32 v72, v72, v24
    v_cvt_pk_bf16_f32 v72, v72, v72
    v_lshlrev_b32 v72, 16, v72
    v_mul_f32 v28, 0xbfb8aa3b, v72
    v_exp_f32 v28, v28
    s_nop 0
    v_add_f32 v28, 1.0, v28
    v_rcp_f32 v28, v28
    s_nop 0
    v_mul_f32 v72, v72, v28
    v_cvt_pk_bf16_f32 v72, v72, v72
    v_lshlrev_b32 v72, 16, v72
    v_lshlrev_b32 v29, 16, v152
    v_mul_f32 v72, v72, v29
    v_cvt_pk_bf16_f32 v72, v72, v72
    v_lshlrev_b32 v72, 16, v72
    v_add_f32 v72, v72, v20
    v_cvt_pk_bf16_f32 v73, v73, v73
    v_lshlrev_b32 v73, 16, v73
    v_add_f32 v73, v73, v25
    v_cvt_pk_bf16_f32 v73, v73, v73
    v_lshlrev_b32 v73, 16, v73
    v_mul_f32 v28, 0xbfb8aa3b, v73
    v_exp_f32 v28, v28
    s_nop 0
    v_add_f32 v28, 1.0, v28
    v_rcp_f32 v28, v28
    s_nop 0
    v_mul_f32 v73, v73, v28
    v_cvt_pk_bf16_f32 v73, v73, v73
    v_lshlrev_b32 v73, 16, v73
    v_lshlrev_b32 v29, 16, v153
    v_mul_f32 v73, v73, v29
    v_cvt_pk_bf16_f32 v73, v73, v73
    v_lshlrev_b32 v73, 16, v73
    v_add_f32 v73, v73, v21
    v_cvt_pk_bf16_f32 v74, v74, v74
    v_lshlrev_b32 v74, 16, v74
    v_add_f32 v74, v74, v26
    v_cvt_pk_bf16_f32 v74, v74, v74
    v_lshlrev_b32 v74, 16, v74
    v_mul_f32 v28, 0xbfb8aa3b, v74
    v_exp_f32 v28, v28
    s_nop 0
    v_add_f32 v28, 1.0, v28
    v_rcp_f32 v28, v28
    s_nop 0
    v_mul_f32 v74, v74, v28
    v_cvt_pk_bf16_f32 v74, v74, v74
    v_lshlrev_b32 v74, 16, v74
    v_lshlrev_b32 v29, 16, v154
    v_mul_f32 v74, v74, v29
    v_cvt_pk_bf16_f32 v74, v74, v74
    v_lshlrev_b32 v74, 16, v74
    v_add_f32 v74, v74, v22
    v_cvt_pk_bf16_f32 v75, v75, v75
    v_lshlrev_b32 v75, 16, v75
    v_add_f32 v75, v75, v27
    v_cvt_pk_bf16_f32 v75, v75, v75
    v_lshlrev_b32 v75, 16, v75
    v_mul_f32 v28, 0xbfb8aa3b, v75
    v_exp_f32 v28, v28
    s_nop 0
    v_add_f32 v28, 1.0, v28
    v_rcp_f32 v28, v28
    s_nop 0
    v_mul_f32 v75, v75, v28
    v_cvt_pk_bf16_f32 v75, v75, v75
    v_lshlrev_b32 v75, 16, v75
    v_lshlrev_b32 v29, 16, v155
    v_mul_f32 v75, v75, v29
    v_cvt_pk_bf16_f32 v75, v75, v75
    v_lshlrev_b32 v75, 16, v75
    v_add_f32 v75, v75, v23
    v_cvt_pk_bf16_f32 v34, v72, v73
    v_cvt_pk_bf16_f32 v35, v74, v75
    buffer_store_dwordx2 v[34:35], v14, s[56:59], 0 offen offset:32
    v_lshlrev_b32 v20, 16, v134
    v_and_b32 v21, 0xffff0000, v134
    v_lshlrev_b32 v22, 16, v135
    v_and_b32 v23, 0xffff0000, v135
    v_lshlrev_b32 v24, 16, v142
    v_and_b32 v25, 0xffff0000, v142
    v_lshlrev_b32 v26, 16, v143
    v_and_b32 v27, 0xffff0000, v143
    v_cvt_pk_bf16_f32 v76, v76, v76
    v_lshlrev_b32 v76, 16, v76
    v_add_f32 v76, v76, v24
    v_cvt_pk_bf16_f32 v76, v76, v76
    v_lshlrev_b32 v76, 16, v76
    v_mul_f32 v28, 0xbfb8aa3b, v76
    v_exp_f32 v28, v28
    s_nop 0
    v_add_f32 v28, 1.0, v28
    v_rcp_f32 v28, v28
    s_nop 0
    v_mul_f32 v76, v76, v28
    v_cvt_pk_bf16_f32 v76, v76, v76
    v_lshlrev_b32 v76, 16, v76
    v_lshlrev_b32 v29, 16, v156
    v_mul_f32 v76, v76, v29
    v_cvt_pk_bf16_f32 v76, v76, v76
    v_lshlrev_b32 v76, 16, v76
    v_add_f32 v76, v76, v20
    v_cvt_pk_bf16_f32 v77, v77, v77
    v_lshlrev_b32 v77, 16, v77
    v_add_f32 v77, v77, v25
    v_cvt_pk_bf16_f32 v77, v77, v77
    v_lshlrev_b32 v77, 16, v77
    v_mul_f32 v28, 0xbfb8aa3b, v77
    v_exp_f32 v28, v28
    s_nop 0
    v_add_f32 v28, 1.0, v28
    v_rcp_f32 v28, v28
    s_nop 0
    v_mul_f32 v77, v77, v28
    v_cvt_pk_bf16_f32 v77, v77, v77
    v_lshlrev_b32 v77, 16, v77
    v_lshlrev_b32 v29, 16, v157
    v_mul_f32 v77, v77, v29
    v_cvt_pk_bf16_f32 v77, v77, v77
    v_lshlrev_b32 v77, 16, v77
    v_add_f32 v77, v77, v21
    v_cvt_pk_bf16_f32 v78, v78, v78
    v_lshlrev_b32 v78, 16, v78
    v_add_f32 v78, v78, v26
    v_cvt_pk_bf16_f32 v78, v78, v78
    v_lshlrev_b32 v78, 16, v78
    v_mul_f32 v28, 0xbfb8aa3b, v78
    v_exp_f32 v28, v28
    s_nop 0
    v_add_f32 v28, 1.0, v28
    v_rcp_f32 v28, v28
    s_nop 0
    v_mul_f32 v78, v78, v28
    v_cvt_pk_bf16_f32 v78, v78, v78
    v_lshlrev_b32 v78, 16, v78
    v_lshlrev_b32 v29, 16, v158
    v_mul_f32 v78, v78, v29
    v_cvt_pk_bf16_f32 v78, v78, v78
    v_lshlrev_b32 v78, 16, v78
    v_add_f32 v78, v78, v22
    v_cvt_pk_bf16_f32 v79, v79, v79
    v_lshlrev_b32 v79, 16, v79
    v_add_f32 v79, v79, v27
    v_cvt_pk_bf16_f32 v79, v79, v79
    v_lshlrev_b32 v79, 16, v79
    v_mul_f32 v28, 0xbfb8aa3b, v79
    v_exp_f32 v28, v28
    s_nop 0
    v_add_f32 v28, 1.0, v28
    v_rcp_f32 v28, v28
    s_nop 0
    v_mul_f32 v79, v79, v28
    v_cvt_pk_bf16_f32 v79, v79, v79
    v_lshlrev_b32 v79, 16, v79
    v_lshlrev_b32 v29, 16, v159
    v_mul_f32 v79, v79, v29
    v_cvt_pk_bf16_f32 v79, v79, v79
    v_lshlrev_b32 v79, 16, v79
    v_add_f32 v79, v79, v23
    v_cvt_pk_bf16_f32 v36, v76, v77
    v_cvt_pk_bf16_f32 v37, v78, v79
    buffer_store_dwordx2 v[36:37], v14, s[56:59], 0 offen offset:48
    s_endpgm
.section .rodata,"a"
.p2align 6
.amdhsa_kernel fin_kernel
  .amdhsa_next_free_vgpr 256
  .amdhsa_next_free_sgpr 102
  .amdhsa_accum_offset 256
  .amdhsa_group_segment_fixed_size 0
  .amdhsa_kernarg_size 120
  .amdhsa_user_sgpr_count 2
  .amdhsa_user_sgpr_kernarg_segment_ptr 1
  .amdhsa_system_sgpr_workgroup_id_x 1
.end_amdhsa_kernel
.text
```
